```python
import torch

def _softmax(x, axis=-1):
    return torch.softmax(x, dim=axis)
def _gelu(x):
    return torch.nn.functional.gelu(x, approximate="tanh")
def _silu(x):
    return torch.nn.functional.silu(x)
def _sigmoid(x):
    return torch.sigmoid(x)
def _layernorm(x, axis=-1, eps=1e-5):
    m = x.mean(dim=axis, keepdim=True)
    v = x.var(dim=axis, keepdim=True, unbiased=False)
    return (x - m) / torch.sqrt(v + eps)
def _scatter_add(tgt, idx, src, axis=0):
    return tgt.clone().index_add_(axis, idx, src)
def _segment_sum(src, seg, n):
    out = torch.zeros((n,) + src.shape[1:], dtype=src.dtype)
    return out.index_add_(0, seg, src)
def _pad(x, pw):
    flat = tuple(v for pair in reversed(pw) for v in pair)
    return torch.nn.functional.pad(x, flat)

kernel_name = 'parallel_sum__ssm_conv_h3__glu_gated_reglu__prompt'

def setup_inputs():

    _w = (lambda a: (lambda t: t.to(torch.bfloat16) if t.is_floating_point() else t)(torch.as_tensor(a)))
    def _A_setup():
        B, S, D = 1, 2048, 448
        ks = 4
        return {
            "q": _w((lambda *s: torch.randn(*s, dtype=torch.bfloat16) * 0.05)(B, S, D)),
            "k": _w((lambda *s: torch.randn(*s, dtype=torch.bfloat16) * 0.2)(B, S, D)),
            "v": _w((lambda *s: torch.randn(*s, dtype=torch.bfloat16) * 0.2)(B, S, D)),
            "shift_k": _w((lambda *s: torch.randn(*s, dtype=torch.bfloat16) * 0.2)(D, ks) * 0.5),
            "ssm_k": _w((lambda *s: torch.randn(*s, dtype=torch.bfloat16) * 0.4)(D, S) * (1.0 / S ** 0.5)),
            "ssm_D": _w((lambda *s: torch.randn(*s, dtype=torch.bfloat16) * 0.2)(D)),
        }
    _A_in = _A_setup()

    def _B_setup():
        B, S, D, F = 1, 2048, 448, 1792
        return {
            "x": _w((lambda *s: torch.randn(*s, dtype=torch.bfloat16) * 0.05)(B, S, D)),
            "W_gate": _w((lambda *s: torch.randn(*s, dtype=torch.bfloat16) * 0.2)(D, F) * (2.0 / D) ** 0.5),
            "W_up": _w((lambda *s: torch.randn(*s, dtype=torch.bfloat16) * 0.2)(D, F) * (2.0 / D) ** 0.5),
            "W_down": _w((lambda *s: torch.randn(*s, dtype=torch.bfloat16) * 0.2)(F, D) * (1.0 / F) ** 0.5),
        }
    _B_in = _B_setup()

    return {
        "A_q": _A_in["q"],
        "A_k": _A_in["k"],
        "A_v": _A_in["v"],
        "A_shift_k": _A_in["shift_k"],
        "A_ssm_k": _A_in["ssm_k"],
        "A_ssm_D": _A_in["ssm_D"],
        "B_x": _B_in["x"],
        "B_W_gate": _B_in["W_gate"],
        "B_W_up": _B_in["W_up"],
        "B_W_down": _B_in["W_down"],
    }

def reference(A_q, A_k, A_v, A_shift_k, A_ssm_k, A_ssm_D, B_x, B_W_gate, B_W_up, B_W_down):
    def _A_ref(q, k, v, shift_k, ssm_k, ssm_D):
        B, S, D = q.shape
        ks = shift_k.shape[-1]
        k_pad = _pad(k, ((0, 0), (ks - 1, 0), (0, 0)))
        k_shift = torch.zeros_like(k)
        for t in range(ks):
            k_shift = k_shift + k_pad[:, t:t + S, :] * shift_k[:, ks - 1 - t][None, None, :]
        kv = k_shift * v
        L = 2 * S
        kv_pad = _pad(kv, ((0, 0), (0, S), (0, 0)))
        kf_pad = _pad(ssm_k, ((0, 0), (0, S)))
        kv_f = (lambda x, axes=(-2,-1): torch.fft.rfft2(x.float(), dim=axes))(kv_pad[:, None, :, :], axes=(1, 2))
        kf_f = (lambda x, axes=(-2,-1): torch.fft.rfft2(x.float(), dim=axes))(kf_pad[:, None, :], axes=(1, 2))
        kf_f = (lambda x, *d: x.permute(*d))(kf_f, 1, 2, 0)
        y_f = kv_f * kf_f[None, :, :, :]
        y = (lambda x, s, axes=(-2,-1): torch.fft.irfft2(x, s=s, dim=axes).to(torch.bfloat16))(y_f, (1, L), axes=(1, 2))[:, 0, :S, :]
        y = y + kv * ssm_D[None, None, :]
        return q * y

    def _B_ref(x, W_gate, W_up, W_down):
        gate = torch.einsum("bsd,df->bsf", x, W_gate)
        up = torch.einsum("bsd,df->bsf", x, W_up)
        gate = gate * (lambda x, dt: x.to(dt))(gate > 0, gate.dtype)
        h = gate * up
        return torch.einsum("bsf,fd->bsd", h, W_down)

    x = A_q
    xn = _layernorm(x, axis=-1)
    return x + _A_ref(xn, A_k, A_v, A_shift_k, A_ssm_k, A_ssm_D) + _B_ref(xn, B_W_gate, B_W_up, B_W_down)
```

```asm
; @launch grid=(256,1,1) block=(512,1,1) lds=163840
.amdgcn_target "amdgcn-amd-amdhsa--gfx950"
.text
.globl parallel_sum__ssm_conv_h3__glu_gated_reglu__prompt_kernel
.p2align 8
.type parallel_sum__ssm_conv_h3__glu_gated_reglu__prompt_kernel,@function
parallel_sum__ssm_conv_h3__glu_gated_reglu__prompt_kernel:
    s_load_dwordx16 s[4:19], s[0:1], 0
    s_load_dwordx8 s[20:27], s[0:1], 64
    s_load_dwordx2 s[28:29], s[0:1], 96
    s_cmp_ge_u32 s2, 256
    s_cbranch_scc1 L_end
    v_lshrrev_b32 v1, 6, v0
    v_and_b32 v0, 63, v0
    v_readfirstlane_b32 s30, v1
    s_cmp_lt_u32 s2, 32
    s_cbranch_scc1 L_prep
    s_sub_u32 s57, s2, 32
    s_and_b32 s58, s57, 7
    s_lshr_b32 s59, s57, 3
    s_mul_i32 s60, s59, 37
    s_lshr_b32 s60, s60, 8
    s_mul_i32 s61, s60, 7
    s_sub_u32 s55, s59, s61
    s_and_b32 s54, s58, 1
    s_lshr_b32 s58, s58, 1
    s_lshl_b32 s58, s58, 2
    s_add_u32 s52, s58, s60
    s_mul_i32 s58, s54, 7
    s_add_u32 s53, s58, s55
    s_lshl_b32 s56, s52, 1
    s_add_u32 s56, s56, s54
    s_cmp_lt_u32 s30, 4
    s_cbranch_scc1 L_cwave
    s_sub_u32 s62, s30, 4
    s_cmp_ge_u32 s62, 2
    s_cbranch_scc1 L_side
    s_setprio 2
    v_lshrrev_b32 v64, 3, v0
    v_mul_u32_u24 v64, 896, v64
    v_lshrrev_b32 v65, 4, v0
    v_and_b32 v66, 7, v0
    v_xor_b32 v66, v66, v65
    v_lshl_add_u32 v4, v66, 4, v64
    v_xor_b32 v66, 4, v66
    v_lshl_add_u32 v5, v66, 4, v64
    v_mul_u32_u24 v64, 3584, v65
    v_and_b32 v66, 15, v0
    v_lshlrev_b32 v67, 1, v65
    v_xor_b32 v66, v66, v67
    v_lshl_add_u32 v6, v66, 4, v64
    v_xor_b32 v66, 8, v66
    v_lshl_add_u32 v7, v66, 4, v64
    s_lshl_b32 s58, s52, 7
    s_lshl_b32 s59, s62, 6
    s_add_u32 s58, s58, s59
    s_mul_i32 s63, s58, 896
    s_lshl_b32 s64, s62, 13
    s_mul_i32 s58, s62, 114688
    s_lshl_b32 s59, s53, 8
    s_add_u32 s65, s58, s59
    s_add_u32 s66, s64, 49152
    s_add_u32 s67, s64, 98304
    s_waitcnt lgkmcnt(0)
    s_mov_b32 s32, s4
    s_and_b32 s33, s5, 0xffff
    s_mov_b32 s34, 1835008
    s_mov_b32 s35, 0x20000
    s_mov_b32 s36, s18
    s_and_b32 s37, s19, 0xffff
    s_mov_b32 s38, 1605632
    s_mov_b32 s39, 0x20000
    s_mov_b32 s40, s20
    s_and_b32 s41, s21, 0xffff
    s_mov_b32 s42, 1605632
    s_mov_b32 s43, 0x20000
    s_add_u32 m0, s64, 0
    s_add_u32 s58, s63, 0
    buffer_load_dwordx4 v4, s[32:35], s58 offen lds
    s_add_u32 m0, s66, 0
    s_add_u32 s58, s65, 0
    buffer_load_dwordx4 v6, s[36:39], s58 offen lds
    s_add_u32 m0, s67, 0
    s_add_u32 s58, s65, 0
    buffer_load_dwordx4 v7, s[40:43], s58 offen lds
    s_add_u32 m0, s64, 1024
    s_add_u32 s58, s63, 7168
    buffer_load_dwordx4 v5, s[32:35], s58 offen lds
    s_add_u32 m0, s66, 1024
    s_add_u32 s58, s65, 14336
    buffer_load_dwordx4 v6, s[36:39], s58 offen lds
    s_add_u32 m0, s67, 1024
    s_add_u32 s58, s65, 14336
    buffer_load_dwordx4 v7, s[40:43], s58 offen lds
    s_add_u32 m0, s64, 2048
    s_add_u32 s58, s63, 14336
    buffer_load_dwordx4 v4, s[32:35], s58 offen lds
    s_add_u32 m0, s66, 2048
    s_add_u32 s58, s65, 28672
    buffer_load_dwordx4 v6, s[36:39], s58 offen lds
    s_add_u32 m0, s67, 2048
    s_add_u32 s58, s65, 28672
    buffer_load_dwordx4 v7, s[40:43], s58 offen lds
    s_add_u32 m0, s64, 3072
    s_add_u32 s58, s63, 21504
    buffer_load_dwordx4 v5, s[32:35], s58 offen lds
    s_add_u32 m0, s66, 3072
    s_add_u32 s58, s65, 43008
    buffer_load_dwordx4 v6, s[36:39], s58 offen lds
    s_add_u32 m0, s67, 3072
    s_add_u32 s58, s65, 43008
    buffer_load_dwordx4 v7, s[40:43], s58 offen lds
    s_add_u32 m0, s64, 4096
    s_add_u32 s58, s63, 28672
    buffer_load_dwordx4 v4, s[32:35], s58 offen lds
    s_add_u32 m0, s66, 4096
    s_add_u32 s58, s65, 57344
    buffer_load_dwordx4 v6, s[36:39], s58 offen lds
    s_add_u32 m0, s67, 4096
    s_add_u32 s58, s65, 57344
    buffer_load_dwordx4 v7, s[40:43], s58 offen lds
    s_add_u32 m0, s64, 5120
    s_add_u32 s58, s63, 35840
    buffer_load_dwordx4 v5, s[32:35], s58 offen lds
    s_add_u32 m0, s66, 5120
    s_add_u32 s58, s65, 71680
    buffer_load_dwordx4 v6, s[36:39], s58 offen lds
    s_add_u32 m0, s67, 5120
    s_add_u32 s58, s65, 71680
    buffer_load_dwordx4 v7, s[40:43], s58 offen lds
    s_add_u32 m0, s64, 6144
    s_add_u32 s58, s63, 43008
    buffer_load_dwordx4 v4, s[32:35], s58 offen lds
    s_add_u32 m0, s66, 6144
    s_add_u32 s58, s65, 86016
    buffer_load_dwordx4 v6, s[36:39], s58 offen lds
    s_add_u32 m0, s67, 6144
    s_add_u32 s58, s65, 86016
    buffer_load_dwordx4 v7, s[40:43], s58 offen lds
    s_add_u32 m0, s64, 7168
    s_add_u32 s58, s63, 50176
    buffer_load_dwordx4 v5, s[32:35], s58 offen lds
    s_add_u32 m0, s66, 7168
    s_add_u32 s58, s65, 100352
    buffer_load_dwordx4 v6, s[36:39], s58 offen lds
    s_add_u32 m0, s67, 7168
    s_add_u32 s58, s65, 100352
    buffer_load_dwordx4 v7, s[40:43], s58 offen lds
    s_add_u32 m0, s64, 16384
    s_add_u32 s58, s63, 128
    buffer_load_dwordx4 v4, s[32:35], s58 offen lds
    s_add_u32 m0, s66, 16384
    s_add_u32 s58, s65, 229376
    buffer_load_dwordx4 v6, s[36:39], s58 offen lds
    s_add_u32 m0, s67, 16384
    s_add_u32 s58, s65, 229376
    buffer_load_dwordx4 v7, s[40:43], s58 offen lds
    s_add_u32 m0, s64, 17408
    s_add_u32 s58, s63, 7296
    buffer_load_dwordx4 v5, s[32:35], s58 offen lds
    s_add_u32 m0, s66, 17408
    s_add_u32 s58, s65, 243712
    buffer_load_dwordx4 v6, s[36:39], s58 offen lds
    s_add_u32 m0, s67, 17408
    s_add_u32 s58, s65, 243712
    buffer_load_dwordx4 v7, s[40:43], s58 offen lds
    s_add_u32 m0, s64, 18432
    s_add_u32 s58, s63, 14464
    buffer_load_dwordx4 v4, s[32:35], s58 offen lds
    s_add_u32 m0, s66, 18432
    s_add_u32 s58, s65, 258048
    buffer_load_dwordx4 v6, s[36:39], s58 offen lds
    s_add_u32 m0, s67, 18432
    s_add_u32 s58, s65, 258048
    buffer_load_dwordx4 v7, s[40:43], s58 offen lds
    s_add_u32 m0, s64, 19456
    s_add_u32 s58, s63, 21632
    buffer_load_dwordx4 v5, s[32:35], s58 offen lds
    s_add_u32 m0, s66, 19456
    s_add_u32 s58, s65, 272384
    buffer_load_dwordx4 v6, s[36:39], s58 offen lds
    s_add_u32 m0, s67, 19456
    s_add_u32 s58, s65, 272384
    buffer_load_dwordx4 v7, s[40:43], s58 offen lds
    s_add_u32 m0, s64, 20480
    s_add_u32 s58, s63, 28800
    buffer_load_dwordx4 v4, s[32:35], s58 offen lds
    s_add_u32 m0, s66, 20480
    s_add_u32 s58, s65, 286720
    buffer_load_dwordx4 v6, s[36:39], s58 offen lds
    s_add_u32 m0, s67, 20480
    s_add_u32 s58, s65, 286720
    buffer_load_dwordx4 v7, s[40:43], s58 offen lds
    s_mov_b32 s44, s28
    s_and_b32 s45, s29, 0xffff
    s_mov_b32 s46, 268435456
    s_mov_b32 s47, 0x20000
    s_mov_b32 s48, s12
    s_and_b32 s49, s13, 0xffff
    s_mov_b32 s50, 1835008
    s_mov_b32 s51, 0x20000
    s_lshr_b32 s59, s62, 1
    s_lshl_b32 s100, s57, 1
    s_add_u32 s100, s100, s59
    s_and_b32 s101, s62, 1
    s_lshr_b32 s59, s100, 4
    s_lshl_b32 s59, s59, 7
    s_add_u32 s59, s59, 11010048
    v_and_b32 v64, 31, v0
    v_lshlrev_b32 v64, 2, v64
    v_add_u32 v22, s59, v64
    v_bfe_u32 v64, v0, 4, 1
    v_mul_u32_u24 v64, 1792, v64
    v_and_b32 v65, 15, v0
    v_add_u32 v64, v64, v65
    s_lshl_b32 s59, s53, 7
    s_lshl_b32 s60, s62, 6
    s_add_u32 s59, s59, s60
    v_add_u32 v64, s59, v64
    v_lshlrev_b32 v64, 3, v64
    v_add_u32 v10, 11468800, v64
    s_lshl_b32 s59, s52, 7
    s_add_u32 s59, s59, s60
    v_and_b32 v64, 31, v0
    v_add_u32 v64, s59, v64
    v_lshlrev_b32 v64, 4, v64
    v_add_u32 v11, 11436032, v64
    s_waitcnt vmcnt(15)
    s_barrier
    s_add_u32 m0, s64, 21504
    s_add_u32 s58, s63, 35968
    buffer_load_dwordx4 v5, s[32:35], s58 offen lds
    s_add_u32 m0, s66, 21504
    s_add_u32 s58, s65, 301056
    buffer_load_dwordx4 v6, s[36:39], s58 offen lds
    s_add_u32 m0, s67, 21504
    s_add_u32 s58, s65, 301056
    buffer_load_dwordx4 v7, s[40:43], s58 offen lds
    s_add_u32 m0, s64, 22528
    s_add_u32 s58, s63, 43136
    buffer_load_dwordx4 v4, s[32:35], s58 offen lds
    s_add_u32 m0, s66, 22528
    s_add_u32 s58, s65, 315392
    buffer_load_dwordx4 v6, s[36:39], s58 offen lds
    s_add_u32 m0, s67, 22528
    s_add_u32 s58, s65, 315392
    buffer_load_dwordx4 v7, s[40:43], s58 offen lds
    s_add_u32 m0, s64, 23552
    s_add_u32 s58, s63, 50304
    buffer_load_dwordx4 v5, s[32:35], s58 offen lds
    s_add_u32 m0, s66, 23552
    s_add_u32 s58, s65, 329728
    buffer_load_dwordx4 v6, s[36:39], s58 offen lds
    s_add_u32 m0, s67, 23552
    s_add_u32 s58, s65, 329728
    buffer_load_dwordx4 v7, s[40:43], s58 offen lds
    s_add_u32 m0, s64, 32768
    s_add_u32 s58, s63, 256
    buffer_load_dwordx4 v4, s[32:35], s58 offen lds
    s_add_u32 m0, s66, 32768
    s_add_u32 s58, s65, 458752
    buffer_load_dwordx4 v6, s[36:39], s58 offen lds
    s_add_u32 m0, s67, 32768
    s_add_u32 s58, s65, 458752
    buffer_load_dwordx4 v7, s[40:43], s58 offen lds
    s_add_u32 m0, s64, 33792
    s_add_u32 s58, s63, 7424
    buffer_load_dwordx4 v5, s[32:35], s58 offen lds
    s_add_u32 m0, s66, 33792
    s_add_u32 s58, s65, 473088
    buffer_load_dwordx4 v6, s[36:39], s58 offen lds
    s_add_u32 m0, s67, 33792
    s_add_u32 s58, s65, 473088
    buffer_load_dwordx4 v7, s[40:43], s58 offen lds
    s_add_u32 m0, s64, 34816
    s_add_u32 s58, s63, 14592
    buffer_load_dwordx4 v4, s[32:35], s58 offen lds
    s_add_u32 m0, s66, 34816
    s_add_u32 s58, s65, 487424
    buffer_load_dwordx4 v6, s[36:39], s58 offen lds
    s_add_u32 m0, s67, 34816
    s_add_u32 s58, s65, 487424
    buffer_load_dwordx4 v7, s[40:43], s58 offen lds
    s_add_u32 m0, s64, 35840
    s_add_u32 s58, s63, 21760
    buffer_load_dwordx4 v5, s[32:35], s58 offen lds
    s_add_u32 m0, s66, 35840
    s_add_u32 s58, s65, 501760
    buffer_load_dwordx4 v6, s[36:39], s58 offen lds
    s_add_u32 m0, s67, 35840
    s_add_u32 s58, s65, 501760
    buffer_load_dwordx4 v7, s[40:43], s58 offen lds
    s_add_u32 m0, s64, 36864
    s_add_u32 s58, s63, 28928
    buffer_load_dwordx4 v4, s[32:35], s58 offen lds
    s_add_u32 m0, s66, 36864
    s_add_u32 s58, s65, 516096
    buffer_load_dwordx4 v6, s[36:39], s58 offen lds
    s_add_u32 m0, s67, 36864
    s_add_u32 s58, s65, 516096
    buffer_load_dwordx4 v7, s[40:43], s58 offen lds
    s_add_u32 m0, s64, 37888
    s_add_u32 s58, s63, 36096
    buffer_load_dwordx4 v5, s[32:35], s58 offen lds
    s_add_u32 m0, s66, 37888
    s_add_u32 s58, s65, 530432
    buffer_load_dwordx4 v6, s[36:39], s58 offen lds
    s_add_u32 m0, s67, 37888
    s_add_u32 s58, s65, 530432
    buffer_load_dwordx4 v7, s[40:43], s58 offen lds
    s_add_u32 m0, s64, 38912
    s_add_u32 s58, s63, 43264
    buffer_load_dwordx4 v4, s[32:35], s58 offen lds
    s_add_u32 m0, s66, 38912
    s_add_u32 s58, s65, 544768
    buffer_load_dwordx4 v6, s[36:39], s58 offen lds
    s_add_u32 m0, s67, 38912
    s_add_u32 s58, s65, 544768
    buffer_load_dwordx4 v7, s[40:43], s58 offen lds
    s_add_u32 m0, s64, 39936
    s_add_u32 s58, s63, 50432
    buffer_load_dwordx4 v5, s[32:35], s58 offen lds
    s_add_u32 m0, s66, 39936
    s_add_u32 s58, s65, 559104
    buffer_load_dwordx4 v6, s[36:39], s58 offen lds
    s_add_u32 m0, s67, 39936
    s_add_u32 s58, s65, 559104
    buffer_load_dwordx4 v7, s[40:43], s58 offen lds
    s_waitcnt vmcnt(24)
    s_barrier
    v_mov_b32 v64, 11403264
    buffer_load_dword v16, v64, s[44:47], 0 offen sc1
    s_add_u32 m0, s64, 0
    s_add_u32 s58, s63, 384
    buffer_load_dwordx4 v4, s[32:35], s58 offen lds
    s_add_u32 m0, s66, 0
    s_add_u32 s58, s65, 688128
    buffer_load_dwordx4 v6, s[36:39], s58 offen lds
    s_add_u32 m0, s67, 0
    s_add_u32 s58, s65, 688128
    buffer_load_dwordx4 v7, s[40:43], s58 offen lds
    s_add_u32 m0, s64, 1024
    s_add_u32 s58, s63, 7552
    buffer_load_dwordx4 v5, s[32:35], s58 offen lds
    s_add_u32 m0, s66, 1024
    s_add_u32 s58, s65, 702464
    buffer_load_dwordx4 v6, s[36:39], s58 offen lds
    s_add_u32 m0, s67, 1024
    s_add_u32 s58, s65, 702464
    buffer_load_dwordx4 v7, s[40:43], s58 offen lds
    s_add_u32 m0, s64, 2048
    s_add_u32 s58, s63, 14720
    buffer_load_dwordx4 v4, s[32:35], s58 offen lds
    s_add_u32 m0, s66, 2048
    s_add_u32 s58, s65, 716800
    buffer_load_dwordx4 v6, s[36:39], s58 offen lds
    s_add_u32 m0, s67, 2048
    s_add_u32 s58, s65, 716800
    buffer_load_dwordx4 v7, s[40:43], s58 offen lds
    s_add_u32 m0, s64, 3072
    s_add_u32 s58, s63, 21888
    buffer_load_dwordx4 v5, s[32:35], s58 offen lds
    s_add_u32 m0, s66, 3072
    s_add_u32 s58, s65, 731136
    buffer_load_dwordx4 v6, s[36:39], s58 offen lds
    s_add_u32 m0, s67, 3072
    s_add_u32 s58, s65, 731136
    buffer_load_dwordx4 v7, s[40:43], s58 offen lds
    s_add_u32 m0, s64, 4096
    s_add_u32 s58, s63, 29056
    buffer_load_dwordx4 v4, s[32:35], s58 offen lds
    s_add_u32 m0, s66, 4096
    s_add_u32 s58, s65, 745472
    buffer_load_dwordx4 v6, s[36:39], s58 offen lds
    s_add_u32 m0, s67, 4096
    s_add_u32 s58, s65, 745472
    buffer_load_dwordx4 v7, s[40:43], s58 offen lds
    s_add_u32 m0, s64, 5120
    s_add_u32 s58, s63, 36224
    buffer_load_dwordx4 v5, s[32:35], s58 offen lds
    s_add_u32 m0, s66, 5120
    s_add_u32 s58, s65, 759808
    buffer_load_dwordx4 v6, s[36:39], s58 offen lds
    s_add_u32 m0, s67, 5120
    s_add_u32 s58, s65, 759808
    buffer_load_dwordx4 v7, s[40:43], s58 offen lds
    s_add_u32 m0, s64, 6144
    s_add_u32 s58, s63, 43392
    buffer_load_dwordx4 v4, s[32:35], s58 offen lds
    s_add_u32 m0, s66, 6144
    s_add_u32 s58, s65, 774144
    buffer_load_dwordx4 v6, s[36:39], s58 offen lds
    s_add_u32 m0, s67, 6144
    s_add_u32 s58, s65, 774144
    buffer_load_dwordx4 v7, s[40:43], s58 offen lds
    s_add_u32 m0, s64, 7168
    s_add_u32 s58, s63, 50560
    buffer_load_dwordx4 v5, s[32:35], s58 offen lds
    s_add_u32 m0, s66, 7168
    s_add_u32 s58, s65, 788480
    buffer_load_dwordx4 v6, s[36:39], s58 offen lds
    s_add_u32 m0, s67, 7168
    s_add_u32 s58, s65, 788480
    buffer_load_dwordx4 v7, s[40:43], s58 offen lds
    s_waitcnt vmcnt(25)
    s_barrier
    s_add_u32 m0, s64, 16384
    s_add_u32 s58, s63, 512
    buffer_load_dwordx4 v4, s[32:35], s58 offen lds
    s_add_u32 m0, s66, 16384
    s_add_u32 s58, s65, 917504
    buffer_load_dwordx4 v6, s[36:39], s58 offen lds
    s_add_u32 m0, s67, 16384
    s_add_u32 s58, s65, 917504
    buffer_load_dwordx4 v7, s[40:43], s58 offen lds
    s_add_u32 m0, s64, 17408
    s_add_u32 s58, s63, 7680
    buffer_load_dwordx4 v5, s[32:35], s58 offen lds
    s_add_u32 m0, s66, 17408
    s_add_u32 s58, s65, 931840
    buffer_load_dwordx4 v6, s[36:39], s58 offen lds
    s_add_u32 m0, s67, 17408
    s_add_u32 s58, s65, 931840
    buffer_load_dwordx4 v7, s[40:43], s58 offen lds
    s_add_u32 m0, s64, 18432
    s_add_u32 s58, s63, 14848
    buffer_load_dwordx4 v4, s[32:35], s58 offen lds
    s_add_u32 m0, s66, 18432
    s_add_u32 s58, s65, 946176
    buffer_load_dwordx4 v6, s[36:39], s58 offen lds
    s_add_u32 m0, s67, 18432
    s_add_u32 s58, s65, 946176
    buffer_load_dwordx4 v7, s[40:43], s58 offen lds
    s_add_u32 m0, s64, 19456
    s_add_u32 s58, s63, 22016
    buffer_load_dwordx4 v5, s[32:35], s58 offen lds
    s_add_u32 m0, s66, 19456
    s_add_u32 s58, s65, 960512
    buffer_load_dwordx4 v6, s[36:39], s58 offen lds
    s_add_u32 m0, s67, 19456
    s_add_u32 s58, s65, 960512
    buffer_load_dwordx4 v7, s[40:43], s58 offen lds
    s_add_u32 m0, s64, 20480
    s_add_u32 s58, s63, 29184
    buffer_load_dwordx4 v4, s[32:35], s58 offen lds
    s_add_u32 m0, s66, 20480
    s_add_u32 s58, s65, 974848
    buffer_load_dwordx4 v6, s[36:39], s58 offen lds
    s_add_u32 m0, s67, 20480
    s_add_u32 s58, s65, 974848
    buffer_load_dwordx4 v7, s[40:43], s58 offen lds
    s_add_u32 m0, s64, 21504
    s_add_u32 s58, s63, 36352
    buffer_load_dwordx4 v5, s[32:35], s58 offen lds
    s_add_u32 m0, s66, 21504
    s_add_u32 s58, s65, 989184
    buffer_load_dwordx4 v6, s[36:39], s58 offen lds
    s_add_u32 m0, s67, 21504
    s_add_u32 s58, s65, 989184
    buffer_load_dwordx4 v7, s[40:43], s58 offen lds
    s_add_u32 m0, s64, 22528
    s_add_u32 s58, s63, 43520
    buffer_load_dwordx4 v4, s[32:35], s58 offen lds
    s_add_u32 m0, s66, 22528
    s_add_u32 s58, s65, 1003520
    buffer_load_dwordx4 v6, s[36:39], s58 offen lds
    s_add_u32 m0, s67, 22528
    s_add_u32 s58, s65, 1003520
    buffer_load_dwordx4 v7, s[40:43], s58 offen lds
    s_add_u32 m0, s64, 23552
    s_add_u32 s58, s63, 50688
    buffer_load_dwordx4 v5, s[32:35], s58 offen lds
    s_add_u32 m0, s66, 23552
    s_add_u32 s58, s65, 1017856
    buffer_load_dwordx4 v6, s[36:39], s58 offen lds
    s_add_u32 m0, s67, 23552
    s_add_u32 s58, s65, 1017856
    buffer_load_dwordx4 v7, s[40:43], s58 offen lds
    v_mov_b32 v64, 162968
    v_mov_b32 v65, 1
    s_mov_b64 exec, 1
    ds_add_u32 v64, v65
    s_mov_b64 exec, -1
    s_waitcnt vmcnt(24)
    s_barrier
    v_readfirstlane_b32 s31, v16
    s_nop 3
    s_add_u32 s31, s31, 1
    s_add_u32 m0, s64, 32768
    s_add_u32 s58, s63, 640
    buffer_load_dwordx4 v4, s[32:35], s58 offen lds
    s_add_u32 m0, s66, 32768
    s_add_u32 s58, s65, 1146880
    buffer_load_dwordx4 v6, s[36:39], s58 offen lds
    s_add_u32 m0, s67, 32768
    s_add_u32 s58, s65, 1146880
    buffer_load_dwordx4 v7, s[40:43], s58 offen lds
    s_add_u32 m0, s64, 33792
    s_add_u32 s58, s63, 7808
    buffer_load_dwordx4 v5, s[32:35], s58 offen lds
    s_add_u32 m0, s66, 33792
    s_add_u32 s58, s65, 1161216
    buffer_load_dwordx4 v6, s[36:39], s58 offen lds
    s_add_u32 m0, s67, 33792
    s_add_u32 s58, s65, 1161216
    buffer_load_dwordx4 v7, s[40:43], s58 offen lds
    s_add_u32 m0, s64, 34816
    s_add_u32 s58, s63, 14976
    buffer_load_dwordx4 v4, s[32:35], s58 offen lds
    s_add_u32 m0, s66, 34816
    s_add_u32 s58, s65, 1175552
    buffer_load_dwordx4 v6, s[36:39], s58 offen lds
    s_add_u32 m0, s67, 34816
    s_add_u32 s58, s65, 1175552
    buffer_load_dwordx4 v7, s[40:43], s58 offen lds
    s_add_u32 m0, s64, 35840
    s_add_u32 s58, s63, 22144
    buffer_load_dwordx4 v5, s[32:35], s58 offen lds
    s_add_u32 m0, s66, 35840
    s_add_u32 s58, s65, 1189888
    buffer_load_dwordx4 v6, s[36:39], s58 offen lds
    s_add_u32 m0, s67, 35840
    s_add_u32 s58, s65, 1189888
    buffer_load_dwordx4 v7, s[40:43], s58 offen lds
    s_add_u32 m0, s64, 36864
    s_add_u32 s58, s63, 29312
    buffer_load_dwordx4 v4, s[32:35], s58 offen lds
    s_add_u32 m0, s66, 36864
    s_add_u32 s58, s65, 1204224
    buffer_load_dwordx4 v6, s[36:39], s58 offen lds
    s_add_u32 m0, s67, 36864
    s_add_u32 s58, s65, 1204224
    buffer_load_dwordx4 v7, s[40:43], s58 offen lds
    s_add_u32 m0, s64, 37888
    s_add_u32 s58, s63, 36480
    buffer_load_dwordx4 v5, s[32:35], s58 offen lds
    s_add_u32 m0, s66, 37888
    s_add_u32 s58, s65, 1218560
    buffer_load_dwordx4 v6, s[36:39], s58 offen lds
    s_add_u32 m0, s67, 37888
    s_add_u32 s58, s65, 1218560
    buffer_load_dwordx4 v7, s[40:43], s58 offen lds
    s_add_u32 m0, s64, 38912
    s_add_u32 s58, s63, 43648
    buffer_load_dwordx4 v4, s[32:35], s58 offen lds
    s_add_u32 m0, s66, 38912
    s_add_u32 s58, s65, 1232896
    buffer_load_dwordx4 v6, s[36:39], s58 offen lds
    s_add_u32 m0, s67, 38912
    s_add_u32 s58, s65, 1232896
    buffer_load_dwordx4 v7, s[40:43], s58 offen lds
    s_add_u32 m0, s64, 39936
    s_add_u32 s58, s63, 50816
    buffer_load_dwordx4 v5, s[32:35], s58 offen lds
    s_add_u32 m0, s66, 39936
    s_add_u32 s58, s65, 1247232
    buffer_load_dwordx4 v6, s[36:39], s58 offen lds
    s_add_u32 m0, s67, 39936
    s_add_u32 s58, s65, 1247232
    buffer_load_dwordx4 v7, s[40:43], s58 offen lds
    s_waitcnt vmcnt(24)
    s_barrier
    s_add_u32 m0, s64, 0
    s_add_u32 s58, s63, 768
    buffer_load_dwordx4 v4, s[32:35], s58 offen lds
    s_add_u32 m0, s66, 0
    s_add_u32 s58, s65, 1376256
    buffer_load_dwordx4 v6, s[36:39], s58 offen lds
    s_add_u32 m0, s67, 0
    s_add_u32 s58, s65, 1376256
    buffer_load_dwordx4 v7, s[40:43], s58 offen lds
    s_add_u32 m0, s64, 1024
    s_add_u32 s58, s63, 7936
    buffer_load_dwordx4 v5, s[32:35], s58 offen lds
    s_add_u32 m0, s66, 1024
    s_add_u32 s58, s65, 1390592
    buffer_load_dwordx4 v6, s[36:39], s58 offen lds
    s_add_u32 m0, s67, 1024
    s_add_u32 s58, s65, 1390592
    buffer_load_dwordx4 v7, s[40:43], s58 offen lds
    s_add_u32 m0, s64, 2048
    s_add_u32 s58, s63, 15104
    buffer_load_dwordx4 v4, s[32:35], s58 offen lds
    s_add_u32 m0, s66, 2048
    s_add_u32 s58, s65, 1404928
    buffer_load_dwordx4 v6, s[36:39], s58 offen lds
    s_add_u32 m0, s67, 2048
    s_add_u32 s58, s65, 1404928
    buffer_load_dwordx4 v7, s[40:43], s58 offen lds
    s_add_u32 m0, s64, 3072
    s_add_u32 s58, s63, 22272
    buffer_load_dwordx4 v5, s[32:35], s58 offen lds
    s_add_u32 m0, s66, 3072
    s_add_u32 s58, s65, 1419264
    buffer_load_dwordx4 v6, s[36:39], s58 offen lds
    s_add_u32 m0, s67, 3072
    s_add_u32 s58, s65, 1419264
    buffer_load_dwordx4 v7, s[40:43], s58 offen lds
    s_add_u32 m0, s64, 4096
    s_add_u32 s58, s63, 29440
    buffer_load_dwordx4 v4, s[32:35], s58 offen lds
    s_add_u32 m0, s66, 4096
    s_add_u32 s58, s65, 1433600
    buffer_load_dwordx4 v6, s[36:39], s58 offen lds
    s_add_u32 m0, s67, 4096
    s_add_u32 s58, s65, 1433600
    buffer_load_dwordx4 v7, s[40:43], s58 offen lds
    s_add_u32 m0, s64, 5120
    s_add_u32 s58, s63, 36608
    buffer_load_dwordx4 v5, s[32:35], s58 offen lds
    s_add_u32 m0, s66, 5120
    s_add_u32 s58, s65, 1447936
    buffer_load_dwordx4 v6, s[36:39], s58 offen lds
    s_add_u32 m0, s67, 5120
    s_add_u32 s58, s65, 1447936
    buffer_load_dwordx4 v7, s[40:43], s58 offen lds
    s_add_u32 m0, s64, 6144
    s_add_u32 s58, s63, 43776
    buffer_load_dwordx4 v4, s[32:35], s58 offen lds
    s_add_u32 m0, s66, 6144
    s_add_u32 s58, s65, 1462272
    buffer_load_dwordx4 v6, s[36:39], s58 offen lds
    s_add_u32 m0, s67, 6144
    s_add_u32 s58, s65, 1462272
    buffer_load_dwordx4 v7, s[40:43], s58 offen lds
    s_add_u32 m0, s64, 7168
    s_add_u32 s58, s63, 50944
    buffer_load_dwordx4 v5, s[32:35], s58 offen lds
    s_add_u32 m0, s66, 7168
    s_add_u32 s58, s65, 1476608
    buffer_load_dwordx4 v6, s[36:39], s58 offen lds
    s_add_u32 m0, s67, 7168
    s_add_u32 s58, s65, 1476608
    buffer_load_dwordx4 v7, s[40:43], s58 offen lds
    s_waitcnt vmcnt(24)
    s_barrier
    buffer_load_dwordx4 v[80:83], v11, s[44:47], 0 offen offset:0 sc1
    buffer_load_dwordx4 v[84:87], v11, s[44:47], 0 offen offset:512 sc1
    buffer_load_dwordx2 v[72:73], v10, s[44:47], 0 offen offset:0 sc1
    buffer_load_dwordx2 v[74:75], v10, s[44:47], 0 offen offset:128 sc1
    buffer_load_dwordx2 v[76:77], v10, s[44:47], 0 offen offset:256 sc1
    buffer_load_dwordx2 v[78:79], v10, s[44:47], 0 offen offset:384 sc1
    s_waitcnt vmcnt(6)
    s_barrier
    s_waitcnt vmcnt(0)
    s_mov_b32 s68, 65536
L_tag_1:
    v_cmp_ne_u32 vcc, s31, v81
    v_cmp_ne_u32 s[70:71], s31, v83
    s_nop 1
    s_or_b64 vcc, vcc, s[70:71]
    v_cmp_ne_u32 s[70:71], s31, v85
    s_nop 1
    s_or_b64 vcc, vcc, s[70:71]
    v_cmp_ne_u32 s[70:71], s31, v87
    s_nop 1
    s_or_b64 vcc, vcc, s[70:71]
    s_cbranch_vccz L_tagd_2
    buffer_load_dwordx4 v[80:83], v11, s[44:47], 0 offen offset:0 sc1
    buffer_load_dwordx4 v[84:87], v11, s[44:47], 0 offen offset:512 sc1
    s_waitcnt vmcnt(0)
    s_sub_u32 s68, s68, 1
    s_cmp_lg_u32 s68, 0
    s_cbranch_scc1 L_tag_1
L_tagd_2:
    v_and_b32 v65, 31, v0
    s_lshl_b32 s59, s62, 9
    v_lshl_add_u32 v67, v65, 3, s59
    v_add_u32 v98, 161792, v67
    v_add_u32 v99, 157696, v67
    v_mov_b32 v81, v82
    ds_write_b64 v98, v[80:81] offset:0
    v_cvt_pk_bf16_f32 v68, -v80, -v80
    v_and_b32 v66, 0xffff0000, v68
    v_sub_f32_e64 v66, -v80, v66
    v_cvt_pk_bf16_f32 v69, v66, v66
    v_and_b32 v89, 0xffff, v68
    v_lshlrev_b32 v65, 16, v69
    v_or_b32 v88, v65, v89
    ds_write_b64 v99, v[88:89] offset:0
    v_mov_b32 v85, v86
    ds_write_b64 v98, v[84:85] offset:256
    v_cvt_pk_bf16_f32 v68, -v84, -v84
    v_and_b32 v66, 0xffff0000, v68
    v_sub_f32_e64 v66, -v84, v66
    v_cvt_pk_bf16_f32 v69, v66, v66
    v_and_b32 v91, 0xffff, v68
    v_lshlrev_b32 v65, 16, v69
    v_or_b32 v90, v65, v91
    ds_write_b64 v99, v[90:91] offset:256
    s_mov_b32 s68, 65536
L_tag_3:
    v_cmp_ne_u32 vcc, s31, v73
    v_cmp_ne_u32 s[70:71], s31, v75
    s_nop 1
    s_or_b64 vcc, vcc, s[70:71]
    v_cmp_ne_u32 s[70:71], s31, v77
    s_nop 1
    s_or_b64 vcc, vcc, s[70:71]
    v_cmp_ne_u32 s[70:71], s31, v79
    s_nop 1
    s_or_b64 vcc, vcc, s[70:71]
    s_cbranch_vccz L_tagd_4
    buffer_load_dwordx2 v[72:73], v10, s[44:47], 0 offen offset:0 sc1
    buffer_load_dwordx2 v[74:75], v10, s[44:47], 0 offen offset:128 sc1
    buffer_load_dwordx2 v[76:77], v10, s[44:47], 0 offen offset:256 sc1
    buffer_load_dwordx2 v[78:79], v10, s[44:47], 0 offen offset:384 sc1
    s_waitcnt vmcnt(0)
    s_sub_u32 s68, s68, 1
    s_cmp_lg_u32 s68, 0
    s_cbranch_scc1 L_tag_3
L_tagd_4:
    v_and_b32 v65, 31, v0
    s_lshl_b32 s59, s62, 10
    v_lshl_add_u32 v67, v65, 3, s59
    v_add_u32 v99, 158720, v67
    v_cvt_pk_bf16_f32 v68, v72, v72
    v_and_b32 v66, 0xffff0000, v68
    v_sub_f32_e64 v66, v72, v66
    v_cvt_pk_bf16_f32 v69, v66, v66
    v_mov_b32 v92, v68
    v_and_b32 v93, 0xffff, v69
    ds_write_b64 v99, v[92:93] offset:0
    v_cvt_pk_bf16_f32 v68, v74, v74
    v_and_b32 v66, 0xffff0000, v68
    v_sub_f32_e64 v66, v74, v66
    v_cvt_pk_bf16_f32 v69, v66, v66
    v_mov_b32 v94, v68
    v_and_b32 v95, 0xffff, v69
    ds_write_b64 v99, v[94:95] offset:256
    v_cvt_pk_bf16_f32 v68, v76, v76
    v_and_b32 v66, 0xffff0000, v68
    v_sub_f32_e64 v66, v76, v66
    v_cvt_pk_bf16_f32 v69, v66, v66
    v_mov_b32 v92, v68
    v_and_b32 v93, 0xffff, v69
    ds_write_b64 v99, v[92:93] offset:512
    v_cvt_pk_bf16_f32 v68, v78, v78
    v_and_b32 v66, 0xffff0000, v68
    v_sub_f32_e64 v66, v78, v66
    v_cvt_pk_bf16_f32 v69, v66, v66
    v_mov_b32 v94, v68
    v_and_b32 v95, 0xffff, v69
    ds_write_b64 v99, v[94:95] offset:768
    v_mov_b32 v65, 0
    v_mov_b32 v66, 162820
    ds_write_b32 v66, v65
    s_waitcnt lgkmcnt(0)
    s_branch L_htail
L_side:
    s_setprio 2
    s_sub_u32 s63, s62, 2
    s_mul_i32 s64, s57, 9363
    s_lshr_b32 s64, s64, 16
    s_mul_i32 s59, s64, 7
    s_sub_u32 s65, s57, s59
    s_lshl_b32 s58, s64, 6
    s_lshl_b32 s59, s63, 5
    s_add_u32 s58, s58, s59
    v_lshrrev_b32 v64, 3, v0
    v_lshl_add_u32 v65, v64, 2, s58
    v_and_b32 v66, 7, v0
    s_lshl_b32 s59, s65, 7
    v_lshl_add_u32 v67, v66, 4, s59
    v_mov_b32 v191, 896
    v_mad_u32_u24 v189, v65, v191, v67
    v_cmp_gt_u32 vcc, 3, v65
    v_subrev_u32 v186, 2688, v189
    v_mov_b32 v191, 0x40000000
    v_cndmask_b32 v186, v186, v191, vcc
    v_cmp_gt_u32 vcc, 2, v65
    v_subrev_u32 v187, 1792, v189
    v_mov_b32 v191, 0x40000000
    v_cndmask_b32 v187, v187, v191, vcc
    v_cmp_gt_u32 vcc, 1, v65
    v_subrev_u32 v188, 896, v189
    v_mov_b32 v191, 0x40000000
    v_cndmask_b32 v188, v188, v191, vcc
    s_lshl_b32 s59, s65, 9
    v_lshl_add_u32 v190, v66, 6, s59
    v_lshrrev_b32 v65, 1, v64
    s_lshl_b32 s59, s63, 2
    v_add_u32 v65, s59, v65
    v_xor_b32 v65, v65, v66
    v_lshlrev_b32 v65, 4, v65
    v_lshl_add_u32 v65, v66, 10, v65
    v_and_b32 v64, 1, v64
    v_sub_u32 v64, 1, v64
    v_lshl_add_u32 v65, v64, 3, v65
    v_add_u32 v191, 149504, v65
    s_waitcnt lgkmcnt(0)
    s_mov_b32 s32, s4
    s_and_b32 s33, s5, 0xffff
    s_mov_b32 s34, 1835008
    s_mov_b32 s35, 0x20000
    s_mov_b32 s36, s6
    s_and_b32 s37, s7, 0xffff
    s_mov_b32 s38, 1835008
    s_mov_b32 s39, 0x20000
    s_mov_b32 s40, s8
    s_and_b32 s41, s9, 0xffff
    s_mov_b32 s42, 1835008
    s_mov_b32 s43, 0x20000
    s_mov_b32 s92, s10
    s_and_b32 s93, s11, 0xffff
    s_mov_b32 s94, 3584
    s_mov_b32 s95, 0x20000
    s_mov_b32 s44, s28
    s_and_b32 s45, s29, 0xffff
    s_mov_b32 s46, 268435456
    s_mov_b32 s47, 0x20000
    s_mov_b32 s48, s12
    s_and_b32 s49, s13, 0xffff
    s_mov_b32 s50, 1835008
    s_mov_b32 s51, 0x20000
    s_lshr_b32 s59, s62, 1
    s_lshl_b32 s100, s57, 1
    s_add_u32 s100, s100, s59
    s_and_b32 s101, s62, 1
    s_lshr_b32 s59, s100, 4
    s_lshl_b32 s59, s59, 7
    s_add_u32 s59, s59, 11010048
    v_and_b32 v64, 31, v0
    v_lshlrev_b32 v64, 2, v64
    v_add_u32 v22, s59, v64
    v_mov_b32 v64, 162944
    v_mov_b32 v88, 0
    v_mov_b32 v89, 0
    v_mov_b32 v90, 0
    v_mov_b32 v91, 0
    ds_write_b128 v64, v[88:91]
    ds_write_b128 v64, v[88:91] offset:16
    v_mov_b32 v64, 160768
    ds_write_b64 v64, v[88:89]
    s_lshl_b32 s59, s65, 2
    s_lshl_b32 s60, s63, 1
    s_add_u32 s59, s59, s60
    v_add_u32 v64, s59, v0
    v_lshlrev_b32 v64, 5, v64
    v_add_u32 v64, s64, v64
    v_lshlrev_b32 v64, 2, v64
    v_add_u32 v9, 11010048, v64
    s_lshl_b32 s59, s65, 6
    s_lshl_b32 s58, s63, 5
    s_add_u32 s59, s59, s58
    v_lshrrev_b32 v64, 3, v0
    v_add_u32 v64, s59, v64
    v_lshlrev_b32 v64, 12, v64
    s_lshl_b32 s59, s64, 7
    s_add_u32 s59, s59, 7340032
    v_add_u32 v64, s59, v64
    v_and_b32 v65, 7, v0
    s_lshl_b32 s59, s63, 2
    v_xor_b32 v65, s59, v65
    v_xor_b32 v66, 0, v65
    v_lshl_add_u32 v10, v66, 4, v64
    v_xor_b32 v66, 1, v65
    v_lshl_add_u32 v11, v66, 4, v64
    v_add_u32 v11, 32768, v11
    v_xor_b32 v66, 2, v65
    v_lshl_add_u32 v12, v66, 4, v64
    v_add_u32 v12, 65536, v12
    v_xor_b32 v66, 3, v65
    v_lshl_add_u32 v13, v66, 4, v64
    v_add_u32 v13, 98304, v13
    s_barrier
    s_barrier
    v_mov_b32 v64, 11403264
    buffer_load_dword v16, v64, s[44:47], 0 offen sc1
    s_barrier
    v_mov_b32 v64, 162968
    s_mov_b32 s68, 65536
L_lw_5:
    ds_read_b32 v65, v64
    s_waitcnt lgkmcnt(0)
    v_readfirstlane_b32 s61, v65
    s_nop 0
    s_cmp_ge_u32 s61, 2
    s_cbranch_scc1 L_lwd_6
    s_sleep 1
    s_sub_u32 s68, s68, 1
    s_cmp_lg_u32 s68, 0
    s_cbranch_scc1 L_lw_5
L_lwd_6:
    buffer_load_dwordx4 v[100:103], v186, s[36:39], 0 offen
    buffer_load_dwordx4 v[104:107], v187, s[36:39], 0 offen
    buffer_load_dwordx4 v[108:111], v188, s[36:39], 0 offen
    buffer_load_dwordx4 v[112:115], v189, s[36:39], 0 offen offset:0
    buffer_load_dwordx4 v[116:119], v189, s[36:39], 0 offen offset:896
    buffer_load_dwordx4 v[120:123], v189, s[36:39], 0 offen offset:1792
    buffer_load_dwordx4 v[124:127], v189, s[36:39], 0 offen offset:2688
    buffer_load_dwordx4 v[128:131], v189, s[40:43], 0 offen offset:0
    buffer_load_dwordx4 v[132:135], v189, s[40:43], 0 offen offset:896
    buffer_load_dwordx4 v[136:139], v189, s[40:43], 0 offen offset:1792
    buffer_load_dwordx4 v[140:143], v189, s[40:43], 0 offen offset:2688
    buffer_load_dwordx4 v[144:147], v190, s[92:95], 0 offen offset:0
    buffer_load_dwordx4 v[148:151], v190, s[92:95], 0 offen offset:16
    buffer_load_dwordx4 v[152:155], v190, s[92:95], 0 offen offset:32
    buffer_load_dwordx4 v[156:159], v190, s[92:95], 0 offen offset:48
    s_barrier
    s_waitcnt vmcnt(15)
    v_readfirstlane_b32 s31, v16
    s_nop 3
    s_add_u32 s31, s31, 1
    v_mov_b32 v64, s31
    v_mov_b32 v65, 162816
    ds_write_b32 v65, v64
    s_cmp_lg_u32 s63, 0
    s_cbranch_scc1 L_nosg_7
    v_lshlrev_b32 v64, 3, v0
    v_add_u32 v64, 162832, v64
    ds_read_b64 v[66:67], v64
    v_and_b32 v64, 3, v0
    v_lshrrev_b32 v65, 2, v0
    v_mul_u32_u24 v65, 56, v65
    v_add_u32 v64, v64, v65
    s_lshl_b32 s59, s53, 2
    v_add_u32 v64, s59, v64
    v_cmp_gt_u32 vcc, 128, v64
    s_lshl_b32 s59, s52, 7
    v_add_u32 v64, s59, v64
    v_lshlrev_b32 v64, 4, v64
    v_add_u32 v64, 11436032, v64
    s_and_b64 vcc, vcc, 0xfff
    s_waitcnt lgkmcnt(0)
    v_mov_b32 v80, v66
    v_mov_b32 v81, s31
    v_mov_b32 v82, v67
    v_mov_b32 v83, s31
    s_mov_b64 exec, vcc
    buffer_store_dwordx4 v[80:83], v64, s[44:47], 0 offen sc1
    s_mov_b64 exec, -1
L_nosg_7:
    s_waitcnt vmcnt(0)
    v_lshlrev_b32 v174, 16, v144
    v_and_b32 v175, 0xffff0000, v144
    v_lshlrev_b32 v176, 16, v145
    v_and_b32 v177, 0xffff0000, v145
    v_lshlrev_b32 v178, 16, v146
    v_and_b32 v179, 0xffff0000, v146
    v_lshlrev_b32 v180, 16, v147
    v_and_b32 v181, 0xffff0000, v147
    v_lshlrev_b32 v160, 16, v100
    v_and_b32 v167, 0xffff0000, v100
    v_lshlrev_b32 v161, 16, v104
    v_and_b32 v168, 0xffff0000, v104
    v_lshlrev_b32 v162, 16, v108
    v_and_b32 v169, 0xffff0000, v108
    v_lshlrev_b32 v163, 16, v112
    v_and_b32 v170, 0xffff0000, v112
    v_lshlrev_b32 v164, 16, v116
    v_and_b32 v171, 0xffff0000, v116
    v_lshlrev_b32 v165, 16, v120
    v_and_b32 v172, 0xffff0000, v120
    v_lshlrev_b32 v166, 16, v124
    v_and_b32 v173, 0xffff0000, v124
    v_mul_f32 v182, v174, v163
    v_mul_f32 v183, v174, v164
    v_mul_f32 v184, v174, v165
    v_mul_f32 v185, v174, v166
    v_fmac_f32 v182, v175, v162
    v_fmac_f32 v183, v175, v163
    v_fmac_f32 v184, v175, v164
    v_fmac_f32 v185, v175, v165
    v_fmac_f32 v182, v176, v161
    v_fmac_f32 v183, v176, v162
    v_fmac_f32 v184, v176, v163
    v_fmac_f32 v185, v176, v164
    v_fmac_f32 v182, v177, v160
    v_fmac_f32 v183, v177, v161
    v_fmac_f32 v184, v177, v162
    v_fmac_f32 v185, v177, v163
    v_lshlrev_b32 v160, 16, v128
    v_lshlrev_b32 v161, 16, v132
    v_lshlrev_b32 v162, 16, v136
    v_lshlrev_b32 v163, 16, v140
    v_mul_f32 v182, v182, v160
    v_mul_f32 v183, v183, v161
    v_mul_f32 v184, v184, v162
    v_mul_f32 v185, v185, v163
    v_cvt_pk_bf16_f32 v70, v185, v184
    v_cvt_pk_bf16_f32 v71, v183, v182
    ds_write_b64 v191, v[70:71] offset:0
    v_mul_f32 v182, v178, v170
    v_mul_f32 v183, v178, v171
    v_mul_f32 v184, v178, v172
    v_mul_f32 v185, v178, v173
    v_fmac_f32 v182, v179, v169
    v_fmac_f32 v183, v179, v170
    v_fmac_f32 v184, v179, v171
    v_fmac_f32 v185, v179, v172
    v_fmac_f32 v182, v180, v168
    v_fmac_f32 v183, v180, v169
    v_fmac_f32 v184, v180, v170
    v_fmac_f32 v185, v180, v171
    v_fmac_f32 v182, v181, v167
    v_fmac_f32 v183, v181, v168
    v_fmac_f32 v184, v181, v169
    v_fmac_f32 v185, v181, v170
    v_and_b32 v167, 0xffff0000, v128
    v_and_b32 v168, 0xffff0000, v132
    v_and_b32 v169, 0xffff0000, v136
    v_and_b32 v170, 0xffff0000, v140
    v_mul_f32 v182, v182, v167
    v_mul_f32 v183, v183, v168
    v_mul_f32 v184, v184, v169
    v_mul_f32 v185, v185, v170
    v_cvt_pk_bf16_f32 v70, v185, v184
    v_cvt_pk_bf16_f32 v71, v183, v182
    ds_write_b64 v191, v[70:71] offset:128
    v_lshlrev_b32 v174, 16, v148
    v_and_b32 v175, 0xffff0000, v148
    v_lshlrev_b32 v176, 16, v149
    v_and_b32 v177, 0xffff0000, v149
    v_lshlrev_b32 v178, 16, v150
    v_and_b32 v179, 0xffff0000, v150
    v_lshlrev_b32 v180, 16, v151
    v_and_b32 v181, 0xffff0000, v151
    v_lshlrev_b32 v160, 16, v101
    v_and_b32 v167, 0xffff0000, v101
    v_lshlrev_b32 v161, 16, v105
    v_and_b32 v168, 0xffff0000, v105
    v_lshlrev_b32 v162, 16, v109
    v_and_b32 v169, 0xffff0000, v109
    v_lshlrev_b32 v163, 16, v113
    v_and_b32 v170, 0xffff0000, v113
    v_lshlrev_b32 v164, 16, v117
    v_and_b32 v171, 0xffff0000, v117
    v_lshlrev_b32 v165, 16, v121
    v_and_b32 v172, 0xffff0000, v121
    v_lshlrev_b32 v166, 16, v125
    v_and_b32 v173, 0xffff0000, v125
    v_mul_f32 v182, v174, v163
    v_mul_f32 v183, v174, v164
    v_mul_f32 v184, v174, v165
    v_mul_f32 v185, v174, v166
    v_fmac_f32 v182, v175, v162
    v_fmac_f32 v183, v175, v163
    v_fmac_f32 v184, v175, v164
    v_fmac_f32 v185, v175, v165
    v_fmac_f32 v182, v176, v161
    v_fmac_f32 v183, v176, v162
    v_fmac_f32 v184, v176, v163
    v_fmac_f32 v185, v176, v164
    v_fmac_f32 v182, v177, v160
    v_fmac_f32 v183, v177, v161
    v_fmac_f32 v184, v177, v162
    v_fmac_f32 v185, v177, v163
    v_lshlrev_b32 v160, 16, v129
    v_lshlrev_b32 v161, 16, v133
    v_lshlrev_b32 v162, 16, v137
    v_lshlrev_b32 v163, 16, v141
    v_mul_f32 v182, v182, v160
    v_mul_f32 v183, v183, v161
    v_mul_f32 v184, v184, v162
    v_mul_f32 v185, v185, v163
    v_cvt_pk_bf16_f32 v70, v185, v184
    v_cvt_pk_bf16_f32 v71, v183, v182
    ds_write_b64 v191, v[70:71] offset:256
    v_mul_f32 v182, v178, v170
    v_mul_f32 v183, v178, v171
    v_mul_f32 v184, v178, v172
    v_mul_f32 v185, v178, v173
    v_fmac_f32 v182, v179, v169
    v_fmac_f32 v183, v179, v170
    v_fmac_f32 v184, v179, v171
    v_fmac_f32 v185, v179, v172
    v_fmac_f32 v182, v180, v168
    v_fmac_f32 v183, v180, v169
    v_fmac_f32 v184, v180, v170
    v_fmac_f32 v185, v180, v171
    v_fmac_f32 v182, v181, v167
    v_fmac_f32 v183, v181, v168
    v_fmac_f32 v184, v181, v169
    v_fmac_f32 v185, v181, v170
    v_and_b32 v167, 0xffff0000, v129
    v_and_b32 v168, 0xffff0000, v133
    v_and_b32 v169, 0xffff0000, v137
    v_and_b32 v170, 0xffff0000, v141
    v_mul_f32 v182, v182, v167
    v_mul_f32 v183, v183, v168
    v_mul_f32 v184, v184, v169
    v_mul_f32 v185, v185, v170
    v_cvt_pk_bf16_f32 v70, v185, v184
    v_cvt_pk_bf16_f32 v71, v183, v182
    ds_write_b64 v191, v[70:71] offset:384
    s_barrier
    v_lshlrev_b32 v174, 16, v152
    v_and_b32 v175, 0xffff0000, v152
    v_lshlrev_b32 v176, 16, v153
    v_and_b32 v177, 0xffff0000, v153
    v_lshlrev_b32 v178, 16, v154
    v_and_b32 v179, 0xffff0000, v154
    v_lshlrev_b32 v180, 16, v155
    v_and_b32 v181, 0xffff0000, v155
    v_lshlrev_b32 v160, 16, v102
    v_and_b32 v167, 0xffff0000, v102
    v_lshlrev_b32 v161, 16, v106
    v_and_b32 v168, 0xffff0000, v106
    v_lshlrev_b32 v162, 16, v110
    v_and_b32 v169, 0xffff0000, v110
    v_lshlrev_b32 v163, 16, v114
    v_and_b32 v170, 0xffff0000, v114
    v_lshlrev_b32 v164, 16, v118
    v_and_b32 v171, 0xffff0000, v118
    v_lshlrev_b32 v165, 16, v122
    v_and_b32 v172, 0xffff0000, v122
    v_lshlrev_b32 v166, 16, v126
    v_and_b32 v173, 0xffff0000, v126
    v_mul_f32 v182, v174, v163
    v_mul_f32 v183, v174, v164
    v_mul_f32 v184, v174, v165
    v_mul_f32 v185, v174, v166
    v_fmac_f32 v182, v175, v162
    v_fmac_f32 v183, v175, v163
    v_fmac_f32 v184, v175, v164
    v_fmac_f32 v185, v175, v165
    v_fmac_f32 v182, v176, v161
    v_fmac_f32 v183, v176, v162
    v_fmac_f32 v184, v176, v163
    v_fmac_f32 v185, v176, v164
    v_fmac_f32 v182, v177, v160
    v_fmac_f32 v183, v177, v161
    v_fmac_f32 v184, v177, v162
    v_fmac_f32 v185, v177, v163
    v_lshlrev_b32 v160, 16, v130
    v_lshlrev_b32 v161, 16, v134
    v_lshlrev_b32 v162, 16, v138
    v_lshlrev_b32 v163, 16, v142
    v_mul_f32 v182, v182, v160
    v_mul_f32 v183, v183, v161
    v_mul_f32 v184, v184, v162
    v_mul_f32 v185, v185, v163
    v_cvt_pk_bf16_f32 v70, v185, v184
    v_cvt_pk_bf16_f32 v71, v183, v182
    ds_write_b64 v191, v[70:71] offset:512
    v_mul_f32 v182, v178, v170
    v_mul_f32 v183, v178, v171
    v_mul_f32 v184, v178, v172
    v_mul_f32 v185, v178, v173
    v_fmac_f32 v182, v179, v169
    v_fmac_f32 v183, v179, v170
    v_fmac_f32 v184, v179, v171
    v_fmac_f32 v185, v179, v172
    v_fmac_f32 v182, v180, v168
    v_fmac_f32 v183, v180, v169
    v_fmac_f32 v184, v180, v170
    v_fmac_f32 v185, v180, v171
    v_fmac_f32 v182, v181, v167
    v_fmac_f32 v183, v181, v168
    v_fmac_f32 v184, v181, v169
    v_fmac_f32 v185, v181, v170
    v_and_b32 v167, 0xffff0000, v130
    v_and_b32 v168, 0xffff0000, v134
    v_and_b32 v169, 0xffff0000, v138
    v_and_b32 v170, 0xffff0000, v142
    v_mul_f32 v182, v182, v167
    v_mul_f32 v183, v183, v168
    v_mul_f32 v184, v184, v169
    v_mul_f32 v185, v185, v170
    v_cvt_pk_bf16_f32 v70, v185, v184
    v_cvt_pk_bf16_f32 v71, v183, v182
    ds_write_b64 v191, v[70:71] offset:640
    v_lshlrev_b32 v174, 16, v156
    v_and_b32 v175, 0xffff0000, v156
    v_lshlrev_b32 v176, 16, v157
    v_and_b32 v177, 0xffff0000, v157
    v_lshlrev_b32 v178, 16, v158
    v_and_b32 v179, 0xffff0000, v158
    v_lshlrev_b32 v180, 16, v159
    v_and_b32 v181, 0xffff0000, v159
    v_lshlrev_b32 v160, 16, v103
    v_and_b32 v167, 0xffff0000, v103
    v_lshlrev_b32 v161, 16, v107
    v_and_b32 v168, 0xffff0000, v107
    v_lshlrev_b32 v162, 16, v111
    v_and_b32 v169, 0xffff0000, v111
    v_lshlrev_b32 v163, 16, v115
    v_and_b32 v170, 0xffff0000, v115
    v_lshlrev_b32 v164, 16, v119
    v_and_b32 v171, 0xffff0000, v119
    v_lshlrev_b32 v165, 16, v123
    v_and_b32 v172, 0xffff0000, v123
    v_lshlrev_b32 v166, 16, v127
    v_and_b32 v173, 0xffff0000, v127
    v_mul_f32 v182, v174, v163
    v_mul_f32 v183, v174, v164
    v_mul_f32 v184, v174, v165
    v_mul_f32 v185, v174, v166
    v_fmac_f32 v182, v175, v162
    v_fmac_f32 v183, v175, v163
    v_fmac_f32 v184, v175, v164
    v_fmac_f32 v185, v175, v165
    v_fmac_f32 v182, v176, v161
    v_fmac_f32 v183, v176, v162
    v_fmac_f32 v184, v176, v163
    v_fmac_f32 v185, v176, v164
    v_fmac_f32 v182, v177, v160
    v_fmac_f32 v183, v177, v161
    v_fmac_f32 v184, v177, v162
    v_fmac_f32 v185, v177, v163
    v_lshlrev_b32 v160, 16, v131
    v_lshlrev_b32 v161, 16, v135
    v_lshlrev_b32 v162, 16, v139
    v_lshlrev_b32 v163, 16, v143
    v_mul_f32 v182, v182, v160
    v_mul_f32 v183, v183, v161
    v_mul_f32 v184, v184, v162
    v_mul_f32 v185, v185, v163
    v_cvt_pk_bf16_f32 v70, v185, v184
    v_cvt_pk_bf16_f32 v71, v183, v182
    ds_write_b64 v191, v[70:71] offset:768
    v_mul_f32 v182, v178, v170
    v_mul_f32 v183, v178, v171
    v_mul_f32 v184, v178, v172
    v_mul_f32 v185, v178, v173
    v_fmac_f32 v182, v179, v169
    v_fmac_f32 v183, v179, v170
    v_fmac_f32 v184, v179, v171
    v_fmac_f32 v185, v179, v172
    v_fmac_f32 v182, v180, v168
    v_fmac_f32 v183, v180, v169
    v_fmac_f32 v184, v180, v170
    v_fmac_f32 v185, v180, v171
    v_fmac_f32 v182, v181, v167
    v_fmac_f32 v183, v181, v168
    v_fmac_f32 v184, v181, v169
    v_fmac_f32 v185, v181, v170
    v_and_b32 v167, 0xffff0000, v131
    v_and_b32 v168, 0xffff0000, v135
    v_and_b32 v169, 0xffff0000, v139
    v_and_b32 v170, 0xffff0000, v143
    v_mul_f32 v182, v182, v167
    v_mul_f32 v183, v183, v168
    v_mul_f32 v184, v184, v169
    v_mul_f32 v185, v185, v170
    v_cvt_pk_bf16_f32 v70, v185, v184
    v_cvt_pk_bf16_f32 v71, v183, v182
    ds_write_b64 v191, v[70:71] offset:896
    s_waitcnt lgkmcnt(0)
    s_barrier
    s_lshl_b32 s59, s63, 12
    s_add_u32 s59, s59, 149504
    v_lshlrev_b32 v64, 4, v0
    v_add_u32 v64, s59, v64
    ds_read_b128 v[100:103], v64 offset:0
    ds_read_b128 v[104:107], v64 offset:1024
    ds_read_b128 v[108:111], v64 offset:2048
    ds_read_b128 v[112:115], v64 offset:3072
    s_waitcnt lgkmcnt(3)
    buffer_store_dwordx4 v[100:103], v10, s[44:47], 0 offen sc1
    s_waitcnt lgkmcnt(2)
    buffer_store_dwordx4 v[104:107], v11, s[44:47], 0 offen sc1
    s_waitcnt lgkmcnt(1)
    buffer_store_dwordx4 v[108:111], v12, s[44:47], 0 offen sc1
    s_waitcnt lgkmcnt(0)
    buffer_store_dwordx4 v[112:115], v13, s[44:47], 0 offen sc1
    s_lshl_b32 s59, s57, 1
    s_add_u32 s59, s59, s63
    s_lshl_b32 s59, s59, 12
    v_lshlrev_b32 v64, 4, v0
    v_add_u32 v65, 4, v64
    buffer_load_dwordx4 v[32:35], v64, s[48:51], s59 offen offset:0
    buffer_load_dwordx4 v[48:51], v65, s[48:51], s59 offen offset:0
    buffer_load_dwordx4 v[36:39], v64, s[48:51], s59 offen offset:1024
    buffer_load_dwordx4 v[52:55], v65, s[48:51], s59 offen offset:1024
    buffer_load_dwordx4 v[40:43], v64, s[48:51], s59 offen offset:2048
    buffer_load_dwordx4 v[56:59], v65, s[48:51], s59 offen offset:2048
    buffer_load_dwordx4 v[44:47], v64, s[48:51], s59 offen offset:3072
    buffer_load_dwordx4 v[60:63], v65, s[48:51], s59 offen offset:3072
    s_barrier
    s_waitcnt vmcnt(0)
    v_mov_b32 v64, s31
    s_mov_b64 exec, 3
    buffer_store_dword v64, v9, s[44:47], 0 offen sc1
    s_mov_b64 exec, -1
    s_mul_i32 s60, s63, 8320
    s_add_u32 s60, s60, 122880
    s_mul_i32 s61, s63, 4608
    s_add_u32 s61, s61, 139520
    v_lshlrev_b32 v67, 4, v0
    v_add_u32 v65, s60, v67
    ds_write_b128 v65, v[32:35] offset:32
    ds_write_b128 v65, v[36:39] offset:1056
    ds_write_b128 v65, v[40:43] offset:2080
    ds_write_b128 v65, v[44:47] offset:3104
    v_lshlrev_b32 v66, 16, v32
    v_alignbit_b32 v48, v48, v32, 16
    v_alignbit_b32 v49, v49, v33, 16
    v_alignbit_b32 v50, v50, v34, 16
    v_alignbit_b32 v51, v51, v35, 16
    v_alignbit_b32 v52, v52, v36, 16
    v_alignbit_b32 v53, v53, v37, 16
    v_alignbit_b32 v54, v54, v38, 16
    v_alignbit_b32 v55, v55, v39, 16
    v_alignbit_b32 v56, v56, v40, 16
    v_alignbit_b32 v57, v57, v41, 16
    v_alignbit_b32 v58, v58, v42, 16
    v_alignbit_b32 v59, v59, v43, 16
    v_alignbit_b32 v60, v60, v44, 16
    v_alignbit_b32 v61, v61, v45, 16
    v_alignbit_b32 v62, v62, v46, 16
    v_alignbit_b32 v63, v63, v47, 16
    ds_write_b128 v65, v[48:51] offset:4192
    ds_write_b128 v65, v[52:55] offset:5216
    ds_write_b128 v65, v[56:59] offset:6240
    ds_write_b128 v65, v[60:63] offset:7264
    v_readfirstlane_b32 s59, v66
    v_lshlrev_b32 v65, 2, v0
    v_add_u32 v65, s60, v65
    v_cmp_eq_u32 vcc, 7, v0
    v_mov_b32 v66, s59
    v_mov_b32 v88, 0
    v_cndmask_b32 v66, 0, v66, vcc
    s_mov_b64 exec, 0xff
    ds_write_b32 v65, v88
    ds_write_b32 v65, v66 offset:4160
    s_mov_b64 exec, -1
    v_mov_b32 v89, 0
    v_lshlrev_b32 v65, 3, v0
    v_add_u32 v66, s61, v65
    ds_write_b64 v66, v[88:89]
    s_waitcnt lgkmcnt(0)
L_htail:
    s_barrier
    s_setprio 1
    s_lshr_b32 s58, s62, 1
    s_mul_i32 s64, s58, 4608
    s_add_u32 s64, s64, 139520
    s_mul_i32 s63, s58, 8320
    s_add_u32 s63, s63, 122880
    s_mov_b32 s68, 65536
L_poll_8:
    buffer_load_dword v65, v22, s[44:47], 0 offen sc1
    s_waitcnt vmcnt(0)
    v_cmp_ne_u32 vcc, s31, v65
    s_nop 1
    s_cbranch_vccz L_polled_9
    s_sleep 16
    s_sub_u32 s68, s68, 1
    s_cmp_lg_u32 s68, 0
    s_cbranch_scc1 L_poll_8
L_polled_9:
    s_lshl_b32 s59, s100, 12
    s_add_u32 s59, s59, 7340032
    v_lshlrev_b32 v64, 4, v0
    s_add_u32 m0, s64, 512
    s_add_u32 s60, s59, 0
    buffer_load_dwordx4 v64, s[44:47], s60 offen sc1 lds
    s_add_u32 m0, s64, 1536
    s_add_u32 s60, s59, 1024
    buffer_load_dwordx4 v64, s[44:47], s60 offen sc1 lds
    s_add_u32 m0, s64, 2560
    s_add_u32 s60, s59, 2048
    buffer_load_dwordx4 v64, s[44:47], s60 offen sc1 lds
    s_add_u32 m0, s64, 3584
    s_add_u32 s60, s59, 3072
    buffer_load_dwordx4 v64, s[44:47], s60 offen sc1 lds
    s_lshl_b32 s58, s57, 2
    s_load_dword s66, s[14:15], s58
    v_and_b32 v64, 15, v0
    v_lshrrev_b32 v65, 5, v0
    v_bfe_u32 v66, v0, 4, 1
    v_lshlrev_b32 v67, 4, v65
    v_add_u32 v67, v67, v64
    v_add_u32 v67, 9, v67
    v_lshlrev_b32 v12, 3, v66
    v_sub_u32 v67, v67, v12
    v_and_b32 v12, 1, v67
    v_mul_u32_u24 v12, 4158, v12
    v_lshl_add_u32 v67, v67, 1, v12
    s_lshl_b32 s59, s101, 8
    s_add_u32 s60, s63, s59
    v_add_u32 v8, s60, v67
    v_add_u32 v9, 1024, v8
    v_add_u32 v10, 2048, v8
    v_add_u32 v11, 3072, v8
    v_sub_u32 v67, v64, v65
    v_lshlrev_b32 v67, 5, v67
    v_lshl_add_u32 v67, v66, 4, v67
    v_add_u32 v67, 320, v67
    s_sub_u32 s60, s64, s59
    v_add_u32 v12, s60, v67
    v_lshlrev_b32 v67, 5, v64
    v_lshl_add_u32 v67, v65, 4, v67
    v_lshlrev_b32 v13, 3, v66
    v_sub_u32 v67, v67, v13
    v_add_u32 v67, 520, v67
    s_lshl_b32 s59, s101, 11
    s_add_u32 s60, s64, s59
    v_add_u32 v13, s60, v67
    v_lshrrev_b32 v67, 4, v0
    v_lshlrev_b32 v67, 3, v67
    v_lshl_add_u32 v14, v64, 5, v67
    v_lshlrev_b32 v67, 4, v0
    v_add_u32 v15, s63, v67
    s_lshr_b32 s59, s62, 1
    s_lshl_b32 s59, s59, 2
    s_add_u32 s59, s59, 162944
    v_mov_b32 v16, s59
    v_mov_b32 v17, 1
    s_waitcnt vmcnt(0) lgkmcnt(0)
    ds_read_b128 v[128:131], v12 offset:192
    ds_read2_b32 v[96:97], v8 offset0:0 offset1:1
    ds_read2_b32 v[98:99], v8 offset0:2 offset1:3
    ds_read_b128 v[132:135], v12 offset:704
    ds_read2_b32 v[100:101], v8 offset0:128 offset1:129
    ds_read2_b32 v[102:103], v8 offset0:130 offset1:131
    ds_read_b128 v[136:139], v12 offset:1216
    ds_read2_b32 v[104:105], v9 offset0:0 offset1:1
    ds_read2_b32 v[106:107], v9 offset0:2 offset1:3
    ds_read_b128 v[140:143], v12 offset:1728
    ds_read2_b32 v[108:109], v9 offset0:128 offset1:129
    ds_read2_b32 v[110:111], v9 offset0:130 offset1:131
    ds_read_b128 v[144:147], v12 offset:2240
    ds_read2_b32 v[112:113], v10 offset0:0 offset1:1
    ds_read2_b32 v[114:115], v10 offset0:2 offset1:3
    ds_read_b128 v[148:151], v12 offset:2752
    ds_read2_b32 v[116:117], v10 offset0:128 offset1:129
    ds_read2_b32 v[118:119], v10 offset0:130 offset1:131
    ds_read_b128 v[152:155], v12 offset:3264
    ds_read2_b32 v[120:121], v11 offset0:0 offset1:1
    ds_read2_b32 v[122:123], v11 offset0:2 offset1:3
    ds_read_b128 v[156:159], v12 offset:3776
    ds_read2_b32 v[124:125], v11 offset0:128 offset1:129
    ds_read2_b32 v[126:127], v11 offset0:130 offset1:131
    s_waitcnt lgkmcnt(0)
    v_mfma_f32_16x16x32_bf16 v[224:227], v[96:99], v[128:131], 0
    ds_read_b128 v[192:195], v12 offset:128
    v_mfma_f32_16x16x32_bf16 v[228:231], v[96:99], v[132:135], 0
    ds_read2_b32 v[160:161], v8 offset0:16 offset1:17
    v_mfma_f32_16x16x32_bf16 v[232:235], v[96:99], v[136:139], 0
    ds_read2_b32 v[162:163], v8 offset0:18 offset1:19
    v_mfma_f32_16x16x32_bf16 v[236:239], v[96:99], v[140:143], 0
    ds_read_b128 v[196:199], v12 offset:640
    v_mfma_f32_16x16x32_bf16 v[240:243], v[96:99], v[144:147], 0
    ds_read2_b32 v[164:165], v8 offset0:144 offset1:145
    v_mfma_f32_16x16x32_bf16 v[244:247], v[96:99], v[148:151], 0
    ds_read2_b32 v[166:167], v8 offset0:146 offset1:147
    v_mfma_f32_16x16x32_bf16 v[248:251], v[96:99], v[152:155], 0
    ds_read_b128 v[200:203], v12 offset:1152
    v_mfma_f32_16x16x32_bf16 v[252:255], v[96:99], v[156:159], 0
    ds_read2_b32 v[168:169], v9 offset0:16 offset1:17
    v_mfma_f32_16x16x32_bf16 v[228:231], v[100:103], v[128:131], v[228:231]
    ds_read2_b32 v[170:171], v9 offset0:18 offset1:19
    v_mfma_f32_16x16x32_bf16 v[232:235], v[100:103], v[132:135], v[232:235]
    ds_read_b128 v[204:207], v12 offset:1664
    v_mfma_f32_16x16x32_bf16 v[236:239], v[100:103], v[136:139], v[236:239]
    ds_read2_b32 v[172:173], v9 offset0:144 offset1:145
    v_mfma_f32_16x16x32_bf16 v[240:243], v[100:103], v[140:143], v[240:243]
    ds_read2_b32 v[174:175], v9 offset0:146 offset1:147
    v_mfma_f32_16x16x32_bf16 v[244:247], v[100:103], v[144:147], v[244:247]
    ds_read_b128 v[208:211], v12 offset:2176
    v_mfma_f32_16x16x32_bf16 v[248:251], v[100:103], v[148:151], v[248:251]
    ds_read2_b32 v[176:177], v10 offset0:16 offset1:17
    v_mfma_f32_16x16x32_bf16 v[252:255], v[100:103], v[152:155], v[252:255]
    ds_read2_b32 v[178:179], v10 offset0:18 offset1:19
    v_mfma_f32_16x16x32_bf16 v[232:235], v[104:107], v[128:131], v[232:235]
    ds_read_b128 v[212:215], v12 offset:2688
    v_mfma_f32_16x16x32_bf16 v[236:239], v[104:107], v[132:135], v[236:239]
    ds_read2_b32 v[180:181], v10 offset0:144 offset1:145
    v_mfma_f32_16x16x32_bf16 v[240:243], v[104:107], v[136:139], v[240:243]
    ds_read2_b32 v[182:183], v10 offset0:146 offset1:147
    v_mfma_f32_16x16x32_bf16 v[244:247], v[104:107], v[140:143], v[244:247]
    ds_read_b128 v[216:219], v12 offset:3200
    v_mfma_f32_16x16x32_bf16 v[248:251], v[104:107], v[144:147], v[248:251]
    ds_read2_b32 v[184:185], v11 offset0:16 offset1:17
    v_mfma_f32_16x16x32_bf16 v[252:255], v[104:107], v[148:151], v[252:255]
    ds_read2_b32 v[186:187], v11 offset0:18 offset1:19
    v_mfma_f32_16x16x32_bf16 v[236:239], v[108:111], v[128:131], v[236:239]
    ds_read_b128 v[220:223], v12 offset:3712
    v_mfma_f32_16x16x32_bf16 v[240:243], v[108:111], v[132:135], v[240:243]
    ds_read2_b32 v[188:189], v11 offset0:144 offset1:145
    v_mfma_f32_16x16x32_bf16 v[244:247], v[108:111], v[136:139], v[244:247]
    ds_read2_b32 v[190:191], v11 offset0:146 offset1:147
    v_mfma_f32_16x16x32_bf16 v[248:251], v[108:111], v[140:143], v[248:251]
    v_mfma_f32_16x16x32_bf16 v[252:255], v[108:111], v[144:147], v[252:255]
    v_mfma_f32_16x16x32_bf16 v[240:243], v[112:115], v[128:131], v[240:243]
    v_mfma_f32_16x16x32_bf16 v[244:247], v[112:115], v[132:135], v[244:247]
    v_mfma_f32_16x16x32_bf16 v[248:251], v[112:115], v[136:139], v[248:251]
    v_mfma_f32_16x16x32_bf16 v[252:255], v[112:115], v[140:143], v[252:255]
    v_mfma_f32_16x16x32_bf16 v[244:247], v[116:119], v[128:131], v[244:247]
    v_mfma_f32_16x16x32_bf16 v[248:251], v[116:119], v[132:135], v[248:251]
    v_mfma_f32_16x16x32_bf16 v[252:255], v[116:119], v[136:139], v[252:255]
    v_mfma_f32_16x16x32_bf16 v[248:251], v[120:123], v[128:131], v[248:251]
    v_mfma_f32_16x16x32_bf16 v[252:255], v[120:123], v[132:135], v[252:255]
    v_mfma_f32_16x16x32_bf16 v[252:255], v[124:127], v[128:131], v[252:255]
    s_waitcnt lgkmcnt(0)
    v_mfma_f32_16x16x32_bf16 v[224:227], v[160:163], v[192:195], v[224:227]
    ds_read_b128 v[128:131], v12 offset:64
    v_mfma_f32_16x16x32_bf16 v[228:231], v[160:163], v[196:199], v[228:231]
    ds_read2_b32 v[96:97], v8 offset0:32 offset1:33
    v_mfma_f32_16x16x32_bf16 v[232:235], v[160:163], v[200:203], v[232:235]
    ds_read2_b32 v[98:99], v8 offset0:34 offset1:35
    v_mfma_f32_16x16x32_bf16 v[236:239], v[160:163], v[204:207], v[236:239]
    ds_read_b128 v[132:135], v12 offset:576
    v_mfma_f32_16x16x32_bf16 v[240:243], v[160:163], v[208:211], v[240:243]
    ds_read2_b32 v[100:101], v8 offset0:160 offset1:161
    v_mfma_f32_16x16x32_bf16 v[244:247], v[160:163], v[212:215], v[244:247]
    ds_read2_b32 v[102:103], v8 offset0:162 offset1:163
    v_mfma_f32_16x16x32_bf16 v[248:251], v[160:163], v[216:219], v[248:251]
    ds_read_b128 v[136:139], v12 offset:1088
    v_mfma_f32_16x16x32_bf16 v[252:255], v[160:163], v[220:223], v[252:255]
    ds_read2_b32 v[104:105], v9 offset0:32 offset1:33
    v_mfma_f32_16x16x32_bf16 v[228:231], v[164:167], v[192:195], v[228:231]
    ds_read2_b32 v[106:107], v9 offset0:34 offset1:35
    v_mfma_f32_16x16x32_bf16 v[232:235], v[164:167], v[196:199], v[232:235]
    ds_read_b128 v[140:143], v12 offset:1600
    v_mfma_f32_16x16x32_bf16 v[236:239], v[164:167], v[200:203], v[236:239]
    ds_read2_b32 v[108:109], v9 offset0:160 offset1:161
    v_mfma_f32_16x16x32_bf16 v[240:243], v[164:167], v[204:207], v[240:243]
    ds_read2_b32 v[110:111], v9 offset0:162 offset1:163
    v_mfma_f32_16x16x32_bf16 v[244:247], v[164:167], v[208:211], v[244:247]
    ds_read_b128 v[144:147], v12 offset:2112
    v_mfma_f32_16x16x32_bf16 v[248:251], v[164:167], v[212:215], v[248:251]
    ds_read2_b32 v[112:113], v10 offset0:32 offset1:33
    v_mfma_f32_16x16x32_bf16 v[252:255], v[164:167], v[216:219], v[252:255]
    ds_read2_b32 v[114:115], v10 offset0:34 offset1:35
    v_mfma_f32_16x16x32_bf16 v[232:235], v[168:171], v[192:195], v[232:235]
    ds_read_b128 v[148:151], v12 offset:2624
    v_mfma_f32_16x16x32_bf16 v[236:239], v[168:171], v[196:199], v[236:239]
    ds_read2_b32 v[116:117], v10 offset0:160 offset1:161
    v_mfma_f32_16x16x32_bf16 v[240:243], v[168:171], v[200:203], v[240:243]
    ds_read2_b32 v[118:119], v10 offset0:162 offset1:163
    v_mfma_f32_16x16x32_bf16 v[244:247], v[168:171], v[204:207], v[244:247]
    ds_read_b128 v[152:155], v12 offset:3136
    v_mfma_f32_16x16x32_bf16 v[248:251], v[168:171], v[208:211], v[248:251]
    ds_read2_b32 v[120:121], v11 offset0:32 offset1:33
    v_mfma_f32_16x16x32_bf16 v[252:255], v[168:171], v[212:215], v[252:255]
    ds_read2_b32 v[122:123], v11 offset0:34 offset1:35
    v_mfma_f32_16x16x32_bf16 v[236:239], v[172:175], v[192:195], v[236:239]
    ds_read_b128 v[156:159], v12 offset:3648
    v_mfma_f32_16x16x32_bf16 v[240:243], v[172:175], v[196:199], v[240:243]
    ds_read2_b32 v[124:125], v11 offset0:160 offset1:161
    v_mfma_f32_16x16x32_bf16 v[244:247], v[172:175], v[200:203], v[244:247]
    ds_read2_b32 v[126:127], v11 offset0:162 offset1:163
    v_mfma_f32_16x16x32_bf16 v[248:251], v[172:175], v[204:207], v[248:251]
    v_mfma_f32_16x16x32_bf16 v[252:255], v[172:175], v[208:211], v[252:255]
    v_mfma_f32_16x16x32_bf16 v[240:243], v[176:179], v[192:195], v[240:243]
    v_mfma_f32_16x16x32_bf16 v[244:247], v[176:179], v[196:199], v[244:247]
    v_mfma_f32_16x16x32_bf16 v[248:251], v[176:179], v[200:203], v[248:251]
    v_mfma_f32_16x16x32_bf16 v[252:255], v[176:179], v[204:207], v[252:255]
    v_mfma_f32_16x16x32_bf16 v[244:247], v[180:183], v[192:195], v[244:247]
    v_mfma_f32_16x16x32_bf16 v[248:251], v[180:183], v[196:199], v[248:251]
    v_mfma_f32_16x16x32_bf16 v[252:255], v[180:183], v[200:203], v[252:255]
    v_mfma_f32_16x16x32_bf16 v[248:251], v[184:187], v[192:195], v[248:251]
    v_mfma_f32_16x16x32_bf16 v[252:255], v[184:187], v[196:199], v[252:255]
    v_mfma_f32_16x16x32_bf16 v[252:255], v[188:191], v[192:195], v[252:255]
    s_waitcnt lgkmcnt(0)
    v_mfma_f32_16x16x32_bf16 v[224:227], v[96:99], v[128:131], v[224:227]
    ds_read_b128 v[192:195], v12 offset:0
    v_mfma_f32_16x16x32_bf16 v[228:231], v[96:99], v[132:135], v[228:231]
    ds_read2_b32 v[160:161], v8 offset0:48 offset1:49
    v_mfma_f32_16x16x32_bf16 v[232:235], v[96:99], v[136:139], v[232:235]
    ds_read2_b32 v[162:163], v8 offset0:50 offset1:51
    v_mfma_f32_16x16x32_bf16 v[236:239], v[96:99], v[140:143], v[236:239]
    ds_read_b128 v[196:199], v12 offset:512
    v_mfma_f32_16x16x32_bf16 v[240:243], v[96:99], v[144:147], v[240:243]
    ds_read2_b32 v[164:165], v8 offset0:176 offset1:177
    v_mfma_f32_16x16x32_bf16 v[244:247], v[96:99], v[148:151], v[244:247]
    ds_read2_b32 v[166:167], v8 offset0:178 offset1:179
    v_mfma_f32_16x16x32_bf16 v[248:251], v[96:99], v[152:155], v[248:251]
    ds_read_b128 v[200:203], v12 offset:1024
    v_mfma_f32_16x16x32_bf16 v[252:255], v[96:99], v[156:159], v[252:255]
    ds_read2_b32 v[168:169], v9 offset0:48 offset1:49
    v_mfma_f32_16x16x32_bf16 v[228:231], v[100:103], v[128:131], v[228:231]
    ds_read2_b32 v[170:171], v9 offset0:50 offset1:51
    v_mfma_f32_16x16x32_bf16 v[232:235], v[100:103], v[132:135], v[232:235]
    ds_read_b128 v[204:207], v12 offset:1536
    v_mfma_f32_16x16x32_bf16 v[236:239], v[100:103], v[136:139], v[236:239]
    ds_read2_b32 v[172:173], v9 offset0:176 offset1:177
    v_mfma_f32_16x16x32_bf16 v[240:243], v[100:103], v[140:143], v[240:243]
    ds_read2_b32 v[174:175], v9 offset0:178 offset1:179
    v_mfma_f32_16x16x32_bf16 v[244:247], v[100:103], v[144:147], v[244:247]
    ds_read_b128 v[208:211], v12 offset:2048
    v_mfma_f32_16x16x32_bf16 v[248:251], v[100:103], v[148:151], v[248:251]
    ds_read2_b32 v[176:177], v10 offset0:48 offset1:49
    v_mfma_f32_16x16x32_bf16 v[252:255], v[100:103], v[152:155], v[252:255]
    ds_read2_b32 v[178:179], v10 offset0:50 offset1:51
    v_mfma_f32_16x16x32_bf16 v[232:235], v[104:107], v[128:131], v[232:235]
    ds_read_b128 v[212:215], v12 offset:2560
    v_mfma_f32_16x16x32_bf16 v[236:239], v[104:107], v[132:135], v[236:239]
    ds_read2_b32 v[180:181], v10 offset0:176 offset1:177
    v_mfma_f32_16x16x32_bf16 v[240:243], v[104:107], v[136:139], v[240:243]
    ds_read2_b32 v[182:183], v10 offset0:178 offset1:179
    v_mfma_f32_16x16x32_bf16 v[244:247], v[104:107], v[140:143], v[244:247]
    ds_read_b128 v[216:219], v12 offset:3072
    v_mfma_f32_16x16x32_bf16 v[248:251], v[104:107], v[144:147], v[248:251]
    ds_read2_b32 v[184:185], v11 offset0:48 offset1:49
    v_mfma_f32_16x16x32_bf16 v[252:255], v[104:107], v[148:151], v[252:255]
    ds_read2_b32 v[186:187], v11 offset0:50 offset1:51
    v_mfma_f32_16x16x32_bf16 v[236:239], v[108:111], v[128:131], v[236:239]
    ds_read_b128 v[220:223], v12 offset:3584
    v_mfma_f32_16x16x32_bf16 v[240:243], v[108:111], v[132:135], v[240:243]
    ds_read2_b32 v[188:189], v11 offset0:176 offset1:177
    v_mfma_f32_16x16x32_bf16 v[244:247], v[108:111], v[136:139], v[244:247]
    ds_read2_b32 v[190:191], v11 offset0:178 offset1:179
    v_mfma_f32_16x16x32_bf16 v[248:251], v[108:111], v[140:143], v[248:251]
    v_mfma_f32_16x16x32_bf16 v[252:255], v[108:111], v[144:147], v[252:255]
    v_mfma_f32_16x16x32_bf16 v[240:243], v[112:115], v[128:131], v[240:243]
    v_mfma_f32_16x16x32_bf16 v[244:247], v[112:115], v[132:135], v[244:247]
    v_mfma_f32_16x16x32_bf16 v[248:251], v[112:115], v[136:139], v[248:251]
    v_mfma_f32_16x16x32_bf16 v[252:255], v[112:115], v[140:143], v[252:255]
    v_mfma_f32_16x16x32_bf16 v[244:247], v[116:119], v[128:131], v[244:247]
    v_mfma_f32_16x16x32_bf16 v[248:251], v[116:119], v[132:135], v[248:251]
    v_mfma_f32_16x16x32_bf16 v[252:255], v[116:119], v[136:139], v[252:255]
    v_mfma_f32_16x16x32_bf16 v[248:251], v[120:123], v[128:131], v[248:251]
    v_mfma_f32_16x16x32_bf16 v[252:255], v[120:123], v[132:135], v[252:255]
    v_mfma_f32_16x16x32_bf16 v[252:255], v[124:127], v[128:131], v[252:255]
    s_waitcnt lgkmcnt(0)
    v_mfma_f32_16x16x32_bf16 v[224:227], v[160:163], v[192:195], v[224:227]
    v_mfma_f32_16x16x32_bf16 v[228:231], v[160:163], v[196:199], v[228:231]
    v_mfma_f32_16x16x32_bf16 v[232:235], v[160:163], v[200:203], v[232:235]
    v_mfma_f32_16x16x32_bf16 v[236:239], v[160:163], v[204:207], v[236:239]
    v_mfma_f32_16x16x32_bf16 v[240:243], v[160:163], v[208:211], v[240:243]
    v_mfma_f32_16x16x32_bf16 v[244:247], v[160:163], v[212:215], v[244:247]
    v_mfma_f32_16x16x32_bf16 v[248:251], v[160:163], v[216:219], v[248:251]
    v_mfma_f32_16x16x32_bf16 v[252:255], v[160:163], v[220:223], v[252:255]
    v_mfma_f32_16x16x32_bf16 v[228:231], v[164:167], v[192:195], v[228:231]
    v_mfma_f32_16x16x32_bf16 v[232:235], v[164:167], v[196:199], v[232:235]
    v_mfma_f32_16x16x32_bf16 v[236:239], v[164:167], v[200:203], v[236:239]
    v_mfma_f32_16x16x32_bf16 v[240:243], v[164:167], v[204:207], v[240:243]
    v_mfma_f32_16x16x32_bf16 v[244:247], v[164:167], v[208:211], v[244:247]
    v_mfma_f32_16x16x32_bf16 v[248:251], v[164:167], v[212:215], v[248:251]
    v_mfma_f32_16x16x32_bf16 v[252:255], v[164:167], v[216:219], v[252:255]
    v_mfma_f32_16x16x32_bf16 v[232:235], v[168:171], v[192:195], v[232:235]
    v_mfma_f32_16x16x32_bf16 v[236:239], v[168:171], v[196:199], v[236:239]
    v_mfma_f32_16x16x32_bf16 v[240:243], v[168:171], v[200:203], v[240:243]
    v_mfma_f32_16x16x32_bf16 v[244:247], v[168:171], v[204:207], v[244:247]
    v_mfma_f32_16x16x32_bf16 v[248:251], v[168:171], v[208:211], v[248:251]
    v_mfma_f32_16x16x32_bf16 v[252:255], v[168:171], v[212:215], v[252:255]
    v_mfma_f32_16x16x32_bf16 v[236:239], v[172:175], v[192:195], v[236:239]
    v_mfma_f32_16x16x32_bf16 v[240:243], v[172:175], v[196:199], v[240:243]
    v_mfma_f32_16x16x32_bf16 v[244:247], v[172:175], v[200:203], v[244:247]
    v_mfma_f32_16x16x32_bf16 v[248:251], v[172:175], v[204:207], v[248:251]
    v_mfma_f32_16x16x32_bf16 v[252:255], v[172:175], v[208:211], v[252:255]
    v_mfma_f32_16x16x32_bf16 v[240:243], v[176:179], v[192:195], v[240:243]
    v_mfma_f32_16x16x32_bf16 v[244:247], v[176:179], v[196:199], v[244:247]
    v_mfma_f32_16x16x32_bf16 v[248:251], v[176:179], v[200:203], v[248:251]
    v_mfma_f32_16x16x32_bf16 v[252:255], v[176:179], v[204:207], v[252:255]
    v_mfma_f32_16x16x32_bf16 v[244:247], v[180:183], v[192:195], v[244:247]
    v_mfma_f32_16x16x32_bf16 v[248:251], v[180:183], v[196:199], v[248:251]
    v_mfma_f32_16x16x32_bf16 v[252:255], v[180:183], v[200:203], v[252:255]
    v_mfma_f32_16x16x32_bf16 v[248:251], v[184:187], v[192:195], v[248:251]
    v_mfma_f32_16x16x32_bf16 v[252:255], v[184:187], v[196:199], v[252:255]
    v_mfma_f32_16x16x32_bf16 v[252:255], v[188:191], v[192:195], v[252:255]
    s_mov_b64 exec, 1
    ds_add_u32 v16, v17
    s_mov_b64 exec, -1
    s_mov_b32 s68, 65536
L_ps_10:
    ds_read_b32 v64, v16
    s_waitcnt lgkmcnt(0)
    v_readfirstlane_b32 s58, v64
    s_nop 0
    s_cmp_ge_u32 s58, 2
    s_cbranch_scc1 L_psd_11
    s_sub_u32 s68, s68, 1
    s_cmp_lg_u32 s68, 0
    s_cbranch_scc1 L_ps_10
L_psd_11:
    s_cmp_eq_u32 s101, 1
    s_cbranch_scc1 L_r1_12
    ds_write_b128 v15, v[240:243] offset:0
    ds_write_b128 v15, v[244:247] offset:1024
    ds_write_b128 v15, v[248:251] offset:2048
    ds_write_b128 v15, v[252:255] offset:3072
    s_branch L_rd_13
L_r1_12:
    ds_write_b128 v15, v[224:227] offset:4096
    ds_write_b128 v15, v[228:231] offset:5120
    ds_write_b128 v15, v[232:235] offset:6144
    ds_write_b128 v15, v[236:239] offset:7168
    s_waitcnt lgkmcnt(0)
    v_mov_b32 v224, v240
    v_mov_b32 v225, v241
    v_mov_b32 v226, v242
    v_mov_b32 v227, v243
    v_mov_b32 v228, v244
    v_mov_b32 v229, v245
    v_mov_b32 v230, v246
    v_mov_b32 v231, v247
    v_mov_b32 v232, v248
    v_mov_b32 v233, v249
    v_mov_b32 v234, v250
    v_mov_b32 v235, v251
    v_mov_b32 v236, v252
    v_mov_b32 v237, v253
    v_mov_b32 v238, v254
    v_mov_b32 v239, v255
L_rd_13:
    s_waitcnt lgkmcnt(0)
    s_mov_b64 exec, 1
    ds_add_u32 v16, v17
    s_mov_b64 exec, -1
    s_mov_b32 s68, 65536
L_ps_14:
    ds_read_b32 v64, v16
    s_waitcnt lgkmcnt(0)
    v_readfirstlane_b32 s58, v64
    s_nop 0
    s_cmp_ge_u32 s58, 4
    s_cbranch_scc1 L_psd_15
    s_sub_u32 s68, s68, 1
    s_cmp_lg_u32 s68, 0
    s_cbranch_scc1 L_ps_14
L_psd_15:
    s_xor_b32 s59, s101, 1
    s_lshl_b32 s59, s59, 12
    v_add_u32 v15, s59, v15
    ds_read_b128 v[128:131], v15 offset:0
    ds_read_b128 v[132:135], v15 offset:1024
    ds_read_b128 v[136:139], v15 offset:2048
    ds_read_b128 v[140:143], v15 offset:3072
    ds_read_b64 v[96:97], v13 offset:0
    ds_read_b64 v[98:99], v13 offset:512
    ds_read_b64 v[100:101], v13 offset:1024
    ds_read_b64 v[102:103], v13 offset:1536
    s_lshr_b32 s59, s62, 1
    s_lshl_b32 s59, s59, 4
    s_lshr_b32 s66, s66, s59
    s_lshl_b32 s66, s66, 16
    s_lshl_b32 s59, s100, 12
    s_lshl_b32 s60, s101, 11
    s_add_u32 s59, s59, s60
    s_add_u32 s59, s59, 9175040
    s_waitcnt lgkmcnt(0)
    v_and_b32 v144, 0xffff0000, v97
    v_lshlrev_b32 v145, 16, v97
    v_and_b32 v146, 0xffff0000, v96
    v_lshlrev_b32 v147, 16, v96
    v_add_f32 v224, v224, v128
    v_add_f32 v225, v225, v129
    v_add_f32 v226, v226, v130
    v_add_f32 v227, v227, v131
    v_fmac_f32 v224, s66, v144
    v_fmac_f32 v225, s66, v145
    v_fmac_f32 v226, s66, v146
    v_fmac_f32 v227, s66, v147
    v_cvt_pk_bf16_f32 v148, v224, v225
    v_cvt_pk_bf16_f32 v149, v226, v227
    buffer_store_dwordx2 v[148:149], v14, s[44:47], s59 offen offset:0 sc1
    v_and_b32 v144, 0xffff0000, v99
    v_lshlrev_b32 v145, 16, v99
    v_and_b32 v146, 0xffff0000, v98
    v_lshlrev_b32 v147, 16, v98
    v_add_f32 v228, v228, v132
    v_add_f32 v229, v229, v133
    v_add_f32 v230, v230, v134
    v_add_f32 v231, v231, v135
    v_fmac_f32 v228, s66, v144
    v_fmac_f32 v229, s66, v145
    v_fmac_f32 v230, s66, v146
    v_fmac_f32 v231, s66, v147
    v_cvt_pk_bf16_f32 v150, v228, v229
    v_cvt_pk_bf16_f32 v151, v230, v231
    buffer_store_dwordx2 v[150:151], v14, s[44:47], s59 offen offset:512 sc1
    v_and_b32 v144, 0xffff0000, v101
    v_lshlrev_b32 v145, 16, v101
    v_and_b32 v146, 0xffff0000, v100
    v_lshlrev_b32 v147, 16, v100
    v_add_f32 v232, v232, v136
    v_add_f32 v233, v233, v137
    v_add_f32 v234, v234, v138
    v_add_f32 v235, v235, v139
    v_fmac_f32 v232, s66, v144
    v_fmac_f32 v233, s66, v145
    v_fmac_f32 v234, s66, v146
    v_fmac_f32 v235, s66, v147
    v_cvt_pk_bf16_f32 v152, v232, v233
    v_cvt_pk_bf16_f32 v153, v234, v235
    buffer_store_dwordx2 v[152:153], v14, s[44:47], s59 offen offset:1024 sc1
    v_and_b32 v144, 0xffff0000, v103
    v_lshlrev_b32 v145, 16, v103
    v_and_b32 v146, 0xffff0000, v102
    v_lshlrev_b32 v147, 16, v102
    v_add_f32 v236, v236, v140
    v_add_f32 v237, v237, v141
    v_add_f32 v238, v238, v142
    v_add_f32 v239, v239, v143
    v_fmac_f32 v236, s66, v144
    v_fmac_f32 v237, s66, v145
    v_fmac_f32 v238, s66, v146
    v_fmac_f32 v239, s66, v147
    v_cvt_pk_bf16_f32 v154, v236, v237
    v_cvt_pk_bf16_f32 v155, v238, v239
    buffer_store_dwordx2 v[154:155], v14, s[44:47], s59 offen offset:1536 sc1
    s_lshr_b32 s59, s100, 6
    s_lshl_b32 s59, s59, 1
    s_add_u32 s59, s59, s101
    s_lshl_b32 s59, s59, 6
    s_and_b32 s60, s100, 63
    s_add_u32 s59, s59, s60
    s_lshl_b32 s59, s59, 2
    s_add_u32 s59, s59, 11272192
    s_waitcnt vmcnt(0)
    v_mov_b32 v64, s31
    v_mov_b32 v65, 0
    s_mov_b64 exec, 1
    buffer_store_dword v64, v65, s[44:47], s59 offen sc1
    s_mov_b64 exec, -1
    s_setprio 0
    v_lshrrev_b32 v64, 3, v0
    v_mul_u32_u24 v64, 896, v64
    v_and_b32 v65, 7, v0
    v_lshl_add_u32 v8, v65, 4, v64
    s_lshl_b32 s58, s56, 6
    s_lshl_b32 s59, s62, 4
    s_add_u32 s58, s58, s59
    s_mul_i32 s63, s58, 896
    s_lshl_b32 s59, s55, 7
    s_add_u32 s63, s63, s59
    s_add_u32 s60, s63, 7168
    buffer_load_dwordx4 v[36:39], v8, s[32:35], s63 offen
    buffer_load_dwordx4 v[40:43], v8, s[32:35], s60 offen
    s_lshl_b32 s59, s54, 6
    s_lshl_b32 s60, s62, 4
    s_add_u32 s59, s59, s60
    v_lshrrev_b32 v64, 3, v0
    v_add_u32 v64, s59, v64
    v_lshlrev_b32 v64, 3, v64
    v_add_u32 v64, 161792, v64
    ds_read_b64 v[52:53], v64
    ds_read_b64 v[54:55], v64 offset:64
    v_mov_b32 v64, 162956
    s_mov_b32 s68, 65536
L_lw_16:
    ds_read_b32 v65, v64
    s_waitcnt lgkmcnt(0)
    v_readfirstlane_b32 s61, v65
    s_nop 0
    s_cmp_ge_u32 s61, 4
    s_cbranch_scc1 L_lwd_17
    s_sleep 4
    s_sub_u32 s68, s68, 1
    s_cmp_lg_u32 s68, 0
    s_cbranch_scc1 L_lw_16
L_lwd_17:
    s_lshl_b32 s59, s55, 9
    s_lshr_b32 s60, s56, 4
    s_lshl_b32 s60, s60, 8
    s_add_u32 s59, s59, s60
    s_lshl_b32 s60, s62, 6
    s_add_u32 s59, s59, s60
    s_add_u32 s59, s59, 11272192
    v_and_b32 v64, 15, v0
    v_lshlrev_b32 v64, 2, v64
    v_add_u32 v64, s59, v64
    s_mov_b64 exec, 0xffff
    s_mov_b32 s68, 65536
L_poll_18:
    buffer_load_dword v65, v64, s[44:47], 0 offen sc1
    s_waitcnt vmcnt(0)
    v_cmp_ne_u32 vcc, s31, v65
    s_nop 1
    s_cbranch_vccz L_polled_19
    s_sleep 8
    s_sub_u32 s68, s68, 1
    s_cmp_lg_u32 s68, 0
    s_cbranch_scc1 L_poll_18
L_polled_19:
    s_mov_b64 exec, -1
    s_lshl_b32 s59, s55, 6
    s_lshl_b32 s60, s62, 4
    s_add_u32 s59, s59, s60
    s_lshl_b32 s59, s59, 12
    s_lshl_b32 s60, s56, 7
    s_add_u32 s59, s59, s60
    s_add_u32 s59, s59, 9175040
    s_add_u32 s60, s59, 32768
    v_lshrrev_b32 v64, 3, v0
    v_lshlrev_b32 v64, 12, v64
    v_and_b32 v65, 7, v0
    v_lshl_add_u32 v64, v65, 4, v64
    buffer_load_dwordx4 v[44:47], v64, s[44:47], s59 offen sc1
    buffer_load_dwordx4 v[48:51], v64, s[44:47], s60 offen sc1
    v_lshrrev_b32 v64, 3, v0
    v_lshlrev_b32 v64, 7, v64
    s_lshl_b32 s59, s62, 1
    v_xor_b32 v65, s59, v65
    v_lshl_add_u32 v66, v65, 4, v64
    v_xor_b32 v65, 1, v65
    v_lshl_add_u32 v67, v65, 4, v64
    s_lshl_b32 s59, s62, 11
    s_add_u32 s59, s59, 149504
    v_add_u32 v66, s59, v66
    v_add_u32 v67, s59, v67
    s_waitcnt vmcnt(0)
    ds_write_b128 v66, v[44:47]
    ds_write_b128 v67, v[48:51] offset:1024
    v_mov_b32 v64, 162952
    v_mov_b32 v65, 1
    s_waitcnt lgkmcnt(0)
    s_mov_b64 exec, 1
    ds_add_u32 v64, v65
    s_mov_b64 exec, -1
    s_mov_b32 s68, 65536
L_ps_20:
    ds_read_b32 v66, v64
    s_waitcnt lgkmcnt(0)
    v_readfirstlane_b32 s58, v66
    s_nop 0
    s_cmp_ge_u32 s58, 4
    s_cbranch_scc1 L_psd_21
    s_sub_u32 s68, s68, 1
    s_cmp_lg_u32 s68, 0
    s_cbranch_scc1 L_ps_20
L_psd_21:
    v_and_b32 v65, 7, v0
    s_lshl_b32 s59, s62, 1
    v_xor_b32 v66, s59, v65
    v_lshlrev_b32 v65, 10, v65
    v_lshrrev_b32 v64, 3, v0
    v_lshl_add_u32 v65, v64, 1, v65
    v_add_u32 v65, 149504, v65
    v_lshl_add_u32 v64, v66, 4, v65
    v_xor_b32 v66, 1, v66
    v_lshl_add_u32 v66, v66, 4, v65
    ds_read_u16 v96, v64 offset:0
    ds_read_u16 v97, v64 offset:128
    ds_read_u16 v98, v64 offset:256
    ds_read_u16 v99, v64 offset:384
    ds_read_u16 v100, v64 offset:512
    ds_read_u16 v101, v64 offset:640
    ds_read_u16 v102, v64 offset:768
    ds_read_u16 v103, v64 offset:896
    ds_read_u16 v104, v66 offset:0
    ds_read_u16 v105, v66 offset:128
    ds_read_u16 v106, v66 offset:256
    ds_read_u16 v107, v66 offset:384
    ds_read_u16 v108, v66 offset:512
    ds_read_u16 v109, v66 offset:640
    ds_read_u16 v110, v66 offset:768
    ds_read_u16 v111, v66 offset:896
    s_waitcnt lgkmcnt(0)
    v_mul_f32 v32, v53, v53
    v_lshlrev_b32 v64, 16, v36
    v_lshlrev_b32 v66, 16, v96
    v_sub_f32 v67, v64, v52
    v_mul_f32 v67, v67, v53
    v_fma_f32 v16, v67, v66, v64
    v_and_b32 v64, 0xffff0000, v36
    v_lshlrev_b32 v66, 16, v97
    v_sub_f32 v67, v64, v52
    v_mul_f32 v67, v67, v53
    v_fma_f32 v17, v67, v66, v64
    v_lshlrev_b32 v64, 16, v37
    v_lshlrev_b32 v66, 16, v98
    v_sub_f32 v67, v64, v52
    v_mul_f32 v67, v67, v53
    v_fma_f32 v18, v67, v66, v64
    v_and_b32 v64, 0xffff0000, v37
    v_lshlrev_b32 v66, 16, v99
    v_sub_f32 v67, v64, v52
    v_mul_f32 v67, v67, v53
    v_fma_f32 v19, v67, v66, v64
    v_lshlrev_b32 v64, 16, v38
    v_lshlrev_b32 v66, 16, v100
    v_sub_f32 v67, v64, v52
    v_mul_f32 v67, v67, v53
    v_fma_f32 v20, v67, v66, v64
    v_and_b32 v64, 0xffff0000, v38
    v_lshlrev_b32 v66, 16, v101
    v_sub_f32 v67, v64, v52
    v_mul_f32 v67, v67, v53
    v_fma_f32 v21, v67, v66, v64
    v_lshlrev_b32 v64, 16, v39
    v_lshlrev_b32 v66, 16, v102
    v_sub_f32 v67, v64, v52
    v_mul_f32 v67, v67, v53
    v_fma_f32 v22, v67, v66, v64
    v_and_b32 v64, 0xffff0000, v39
    v_lshlrev_b32 v66, 16, v103
    v_sub_f32 v67, v64, v52
    v_mul_f32 v67, v67, v53
    v_fma_f32 v23, v67, v66, v64
    v_mul_f32 v33, v55, v55
    v_lshlrev_b32 v64, 16, v40
    v_lshlrev_b32 v66, 16, v104
    v_sub_f32 v67, v64, v54
    v_mul_f32 v67, v67, v55
    v_fma_f32 v24, v67, v66, v64
    v_and_b32 v64, 0xffff0000, v40
    v_lshlrev_b32 v66, 16, v105
    v_sub_f32 v67, v64, v54
    v_mul_f32 v67, v67, v55
    v_fma_f32 v25, v67, v66, v64
    v_lshlrev_b32 v64, 16, v41
    v_lshlrev_b32 v66, 16, v106
    v_sub_f32 v67, v64, v54
    v_mul_f32 v67, v67, v55
    v_fma_f32 v26, v67, v66, v64
    v_and_b32 v64, 0xffff0000, v41
    v_lshlrev_b32 v66, 16, v107
    v_sub_f32 v67, v64, v54
    v_mul_f32 v67, v67, v55
    v_fma_f32 v27, v67, v66, v64
    v_lshlrev_b32 v64, 16, v42
    v_lshlrev_b32 v66, 16, v108
    v_sub_f32 v67, v64, v54
    v_mul_f32 v67, v67, v55
    v_fma_f32 v28, v67, v66, v64
    v_and_b32 v64, 0xffff0000, v42
    v_lshlrev_b32 v66, 16, v109
    v_sub_f32 v67, v64, v54
    v_mul_f32 v67, v67, v55
    v_fma_f32 v29, v67, v66, v64
    v_lshlrev_b32 v64, 16, v43
    v_lshlrev_b32 v66, 16, v110
    v_sub_f32 v67, v64, v54
    v_mul_f32 v67, v67, v55
    v_fma_f32 v30, v67, v66, v64
    v_and_b32 v64, 0xffff0000, v43
    v_lshlrev_b32 v66, 16, v111
    v_sub_f32 v67, v64, v54
    v_mul_f32 v67, v67, v55
    v_fma_f32 v31, v67, v66, v64
    v_lshrrev_b32 v64, 3, v0
    s_lshl_b32 s59, s62, 4
    v_add_u32 v64, s59, v64
    v_mul_u32_u24 v64, 272, v64
    v_and_b32 v65, 7, v0
    v_lshl_add_u32 v12, v65, 5, v64
    v_add_u32 v13, 61440, v12
    s_mov_b32 s36, s24
    s_and_b32 s37, s25, 0xffff
    s_mov_b32 s38, 1835008
    s_mov_b32 s39, 0x20000
    s_barrier
    ds_read_b128 v[128:131], v12 offset:0
    ds_read_b128 v[132:135], v12 offset:16
    ds_read_b128 v[136:139], v12 offset:30720
    ds_read_b128 v[140:143], v12 offset:30736
    ds_read_b128 v[144:147], v13 offset:0
    ds_read_b128 v[148:151], v13 offset:16
    ds_read_b128 v[152:155], v13 offset:30720
    ds_read_b128 v[156:159], v13 offset:30736
    ds_read_b128 v[160:163], v12 offset:2176
    ds_read_b128 v[164:167], v12 offset:2192
    ds_read_b128 v[168:171], v12 offset:32896
    ds_read_b128 v[172:175], v12 offset:32912
    ds_read_b128 v[176:179], v13 offset:2176
    ds_read_b128 v[180:183], v13 offset:2192
    ds_read_b128 v[184:187], v13 offset:32896
    ds_read_b128 v[188:191], v13 offset:32912
    s_waitcnt lgkmcnt(8)
    v_add_f32 v128, v128, v136
    v_add_f32 v144, v144, v152
    v_add_f32 v129, v129, v137
    v_add_f32 v145, v145, v153
    v_add_f32 v130, v130, v138
    v_add_f32 v146, v146, v154
    v_add_f32 v131, v131, v139
    v_add_f32 v147, v147, v155
    v_add_f32 v132, v132, v140
    v_add_f32 v148, v148, v156
    v_add_f32 v133, v133, v141
    v_add_f32 v149, v149, v157
    v_add_f32 v134, v134, v142
    v_add_f32 v150, v150, v158
    v_add_f32 v135, v135, v143
    v_add_f32 v151, v151, v159
    v_add_f32 v128, v128, v144
    v_add_f32 v129, v129, v145
    v_add_f32 v130, v130, v146
    v_add_f32 v131, v131, v147
    v_add_f32 v132, v132, v148
    v_add_f32 v133, v133, v149
    v_add_f32 v134, v134, v150
    v_add_f32 v135, v135, v151
    v_fmac_f32 v16, v32, v128
    v_fmac_f32 v17, v32, v129
    v_fmac_f32 v18, v32, v130
    v_fmac_f32 v19, v32, v131
    v_fmac_f32 v20, v32, v132
    v_fmac_f32 v21, v32, v133
    v_fmac_f32 v22, v32, v134
    v_fmac_f32 v23, v32, v135
    v_cvt_pk_bf16_f32 v36, v16, v17
    v_cvt_pk_bf16_f32 v37, v18, v19
    v_cvt_pk_bf16_f32 v38, v20, v21
    v_cvt_pk_bf16_f32 v39, v22, v23
    buffer_store_dwordx4 v[36:39], v8, s[36:39], s63 offen
    s_waitcnt lgkmcnt(0)
    v_add_f32 v160, v160, v168
    v_add_f32 v176, v176, v184
    v_add_f32 v161, v161, v169
    v_add_f32 v177, v177, v185
    v_add_f32 v162, v162, v170
    v_add_f32 v178, v178, v186
    v_add_f32 v163, v163, v171
    v_add_f32 v179, v179, v187
    v_add_f32 v164, v164, v172
    v_add_f32 v180, v180, v188
    v_add_f32 v165, v165, v173
    v_add_f32 v181, v181, v189
    v_add_f32 v166, v166, v174
    v_add_f32 v182, v182, v190
    v_add_f32 v167, v167, v175
    v_add_f32 v183, v183, v191
    v_add_f32 v160, v160, v176
    v_add_f32 v161, v161, v177
    v_add_f32 v162, v162, v178
    v_add_f32 v163, v163, v179
    v_add_f32 v164, v164, v180
    v_add_f32 v165, v165, v181
    v_add_f32 v166, v166, v182
    v_add_f32 v167, v167, v183
    v_fmac_f32 v24, v33, v160
    v_fmac_f32 v25, v33, v161
    v_fmac_f32 v26, v33, v162
    v_fmac_f32 v27, v33, v163
    v_fmac_f32 v28, v33, v164
    v_fmac_f32 v29, v33, v165
    v_fmac_f32 v30, v33, v166
    v_fmac_f32 v31, v33, v167
    v_cvt_pk_bf16_f32 v40, v24, v25
    v_cvt_pk_bf16_f32 v41, v26, v27
    v_cvt_pk_bf16_f32 v42, v28, v29
    v_cvt_pk_bf16_f32 v43, v30, v31
    s_add_u32 s60, s63, 7168
    buffer_store_dwordx4 v[40:43], v8, s[36:39], s60 offen
L_hout:
    s_endpgm
L_cwave:
    v_lshlrev_b32 v17, 4, v0
    s_waitcnt lgkmcnt(0)
    s_mov_b32 s36, s4
    s_and_b32 s37, s5, 0xffff
    s_mov_b32 s38, 1835008
    s_mov_b32 s39, 0x20000
    s_lshl_b32 s58, s53, 2
    s_add_u32 s58, s58, s30
    s_lshl_b32 s59, s52, 7
    s_add_u32 s59, s59, s58
    s_mul_i32 s59, s59, 896
    v_mov_b32 v5, 0x40000000
    v_cmp_gt_u32 vcc, 56, v0
    s_add_u32 s60, s59, 50176
    s_add_u32 s61, s59, 100352
    v_cndmask_b32 v4, v5, v17, vcc
    buffer_load_dwordx4 v[24:27], v4, s[36:39], s59 offen
    buffer_load_dwordx4 v[28:31], v4, s[36:39], s60 offen
    s_cmp_lt_u32 s58, 16
    s_cselect_b32 s61, s61, s60
    buffer_load_dwordx4 v[32:35], v4, s[36:39], s61 offen
    s_lshr_b32 s62, s30, 1
    s_and_b32 s63, s30, 1
    s_lshl_b32 s59, s62, 6
    v_and_b32 v4, 31, v0
    v_bfe_u32 v5, v0, 1, 3
    v_add_u32 v4, s59, v4
    v_lshlrev_b32 v4, 7, v4
    v_lshrrev_b32 v6, 5, v0
    v_xor_b32 v5, v5, v6
    v_xor_b32 v6, 0, v5
    v_lshl_add_u32 v8, v6, 4, v4
    v_xor_b32 v6, 2, v5
    v_lshl_add_u32 v9, v6, 4, v4
    v_xor_b32 v6, 4, v5
    v_lshl_add_u32 v10, v6, 4, v4
    v_xor_b32 v6, 6, v5
    v_lshl_add_u32 v11, v6, 4, v4
    v_bfe_u32 v4, v0, 2, 2
    v_bfe_u32 v5, v0, 1, 1
    v_lshlrev_b32 v16, 1, v4
    v_xor_b32 v16, v16, v5
    v_bfe_u32 v5, v0, 4, 1
    v_lshlrev_b32 v7, 3, v5
    v_xor_b32 v16, v16, v7
    v_mul_u32_u24 v7, 49152, v5
    v_lshrrev_b32 v5, 5, v0
    v_lshl_add_u32 v4, v5, 3, v4
    v_lshl_add_u32 v7, v4, 8, v7
    v_and_b32 v4, 1, v0
    v_lshl_add_u32 v7, v4, 3, v7
    v_add_u32 v7, 49152, v7
    s_lshl_b32 s59, s63, 3
    v_xor_b32 v16, s59, v16
    v_xor_b32 v4, 0, v16
    v_lshl_add_u32 v12, v4, 4, v7
    v_xor_b32 v4, 2, v16
    v_lshl_add_u32 v13, v4, 4, v7
    v_xor_b32 v4, 4, v16
    v_lshl_add_u32 v14, v4, 4, v7
    v_xor_b32 v4, 6, v16
    v_lshl_add_u32 v15, v4, 4, v7
    s_mov_b32 s44, s28
    s_and_b32 s45, s29, 0xffff
    s_mov_b32 s46, 268435456
    s_mov_b32 s47, 0x20000
    s_mov_b32 s32, s22
    s_and_b32 s33, s23, 0xffff
    s_mov_b32 s34, 1605632
    s_mov_b32 s35, 0x20000
    v_lshlrev_b32 v4, 3, v0
    v_cmp_gt_u32 vcc, 32, v0
    s_lshl_b32 s59, s62, 9
    s_add_u32 s59, s59, 157696
    v_add_u32 v18, s59, v4
    v_add_u32 v20, 256, v18
    v_mov_b32 v5, 160768
    v_cndmask_b32 v18, v5, v18, vcc
    v_cndmask_b32 v20, v5, v20, vcc
    v_and_b32 v4, 0xff, v4
    s_lshl_b32 s59, s63, 10
    s_add_u32 s59, s59, 158720
    v_add_u32 v19, s59, v4
    s_lshl_b32 s58, s30, 3
    s_add_u32 s58, s58, 162832
    v_mov_b32 v50, s58
    s_barrier
    s_lshr_b32 s67, s57, 3
    s_mul_i32 s67, s67, 57344
    s_mul_i32 s58, s30, 14336
    s_add_u32 s67, s67, s58
    ds_read_b128 v[96:99], v8 offset:0
    ds_read_b64_tr_b16 v[64:65], v12 offset:0
    ds_read_b64_tr_b16 v[66:67], v12 offset:1024
    ds_read_b128 v[100:103], v8 offset:4096
    ds_read_b64_tr_b16 v[68:69], v13 offset:0
    ds_read_b64_tr_b16 v[70:71], v13 offset:1024
    ds_read_b64_tr_b16 v[72:73], v14 offset:0
    ds_read_b64_tr_b16 v[74:75], v14 offset:1024
    ds_read_b64_tr_b16 v[76:77], v15 offset:0
    ds_read_b64_tr_b16 v[78:79], v15 offset:1024
    s_waitcnt lgkmcnt(0)
    v_mfma_f32_32x32x16_bf16 v[128:143], v[64:67], v[96:99], 0
    ds_read_b128 v[104:107], v9 offset:0
    ds_read_b64_tr_b16 v[80:81], v12 offset:4096
    v_mfma_f32_32x32x16_bf16 v[144:159], v[64:67], v[100:103], 0
    ds_read_b64_tr_b16 v[82:83], v12 offset:5120
    ds_read_b128 v[108:111], v9 offset:4096
    v_mfma_f32_32x32x16_bf16 v[160:175], v[68:71], v[96:99], 0
    ds_read_b64_tr_b16 v[84:85], v13 offset:4096
    ds_read_b64_tr_b16 v[86:87], v13 offset:5120
    v_mfma_f32_32x32x16_bf16 v[176:191], v[68:71], v[100:103], 0
    ds_read_b64_tr_b16 v[88:89], v14 offset:4096
    ds_read_b64_tr_b16 v[90:91], v14 offset:5120
    v_mfma_f32_32x32x16_bf16 v[192:207], v[72:75], v[96:99], 0
    ds_read_b64_tr_b16 v[92:93], v15 offset:4096
    ds_read_b64_tr_b16 v[94:95], v15 offset:5120
    v_mfma_f32_32x32x16_bf16 v[208:223], v[72:75], v[100:103], 0
    v_mfma_f32_32x32x16_bf16 v[224:239], v[76:79], v[96:99], 0
    v_mfma_f32_32x32x16_bf16 v[240:255], v[76:79], v[100:103], 0
    s_waitcnt lgkmcnt(0)
    v_mfma_f32_32x32x16_bf16 v[128:143], v[80:83], v[104:107], v[128:143]
    ds_read_b128 v[96:99], v10 offset:0
    ds_read_b64_tr_b16 v[64:65], v12 offset:8192
    v_mfma_f32_32x32x16_bf16 v[144:159], v[80:83], v[108:111], v[144:159]
    ds_read_b64_tr_b16 v[66:67], v12 offset:9216
    ds_read_b128 v[100:103], v10 offset:4096
    v_mfma_f32_32x32x16_bf16 v[160:175], v[84:87], v[104:107], v[160:175]
    ds_read_b64_tr_b16 v[68:69], v13 offset:8192
    ds_read_b64_tr_b16 v[70:71], v13 offset:9216
    v_mfma_f32_32x32x16_bf16 v[176:191], v[84:87], v[108:111], v[176:191]
    ds_read_b64_tr_b16 v[72:73], v14 offset:8192
    ds_read_b64_tr_b16 v[74:75], v14 offset:9216
    v_mfma_f32_32x32x16_bf16 v[192:207], v[88:91], v[104:107], v[192:207]
    ds_read_b64_tr_b16 v[76:77], v15 offset:8192
    ds_read_b64_tr_b16 v[78:79], v15 offset:9216
    v_mfma_f32_32x32x16_bf16 v[208:223], v[88:91], v[108:111], v[208:223]
    v_mfma_f32_32x32x16_bf16 v[224:239], v[92:95], v[104:107], v[224:239]
    v_mfma_f32_32x32x16_bf16 v[240:255], v[92:95], v[108:111], v[240:255]
    s_waitcnt lgkmcnt(0)
    v_mfma_f32_32x32x16_bf16 v[128:143], v[64:67], v[96:99], v[128:143]
    ds_read_b128 v[104:107], v11 offset:0
    ds_read_b64_tr_b16 v[80:81], v12 offset:12288
    v_mfma_f32_32x32x16_bf16 v[144:159], v[64:67], v[100:103], v[144:159]
    ds_read_b64_tr_b16 v[82:83], v12 offset:13312
    ds_read_b128 v[108:111], v11 offset:4096
    v_mfma_f32_32x32x16_bf16 v[160:175], v[68:71], v[96:99], v[160:175]
    ds_read_b64_tr_b16 v[84:85], v13 offset:12288
    ds_read_b64_tr_b16 v[86:87], v13 offset:13312
    v_mfma_f32_32x32x16_bf16 v[176:191], v[68:71], v[100:103], v[176:191]
    ds_read_b64_tr_b16 v[88:89], v14 offset:12288
    ds_read_b64_tr_b16 v[90:91], v14 offset:13312
    v_mfma_f32_32x32x16_bf16 v[192:207], v[72:75], v[96:99], v[192:207]
    ds_read_b64_tr_b16 v[92:93], v15 offset:12288
    ds_read_b64_tr_b16 v[94:95], v15 offset:13312
    v_mfma_f32_32x32x16_bf16 v[208:223], v[72:75], v[100:103], v[208:223]
    v_mfma_f32_32x32x16_bf16 v[224:239], v[76:79], v[96:99], v[224:239]
    v_mfma_f32_32x32x16_bf16 v[240:255], v[76:79], v[100:103], v[240:255]
    s_waitcnt lgkmcnt(0)
    s_barrier
    v_mfma_f32_32x32x16_bf16 v[128:143], v[80:83], v[104:107], v[128:143]
    ds_read_b128 v[96:99], v8 offset:16384
    ds_read_b64_tr_b16 v[64:65], v12 offset:16384
    v_mfma_f32_32x32x16_bf16 v[144:159], v[80:83], v[108:111], v[144:159]
    ds_read_b64_tr_b16 v[66:67], v12 offset:17408
    ds_read_b128 v[100:103], v8 offset:20480
    v_mfma_f32_32x32x16_bf16 v[160:175], v[84:87], v[104:107], v[160:175]
    ds_read_b64_tr_b16 v[68:69], v13 offset:16384
    ds_read_b64_tr_b16 v[70:71], v13 offset:17408
    v_mfma_f32_32x32x16_bf16 v[176:191], v[84:87], v[108:111], v[176:191]
    ds_read_b64_tr_b16 v[72:73], v14 offset:16384
    ds_read_b64_tr_b16 v[74:75], v14 offset:17408
    v_mfma_f32_32x32x16_bf16 v[192:207], v[88:91], v[104:107], v[192:207]
    ds_read_b64_tr_b16 v[76:77], v15 offset:16384
    ds_read_b64_tr_b16 v[78:79], v15 offset:17408
    v_mfma_f32_32x32x16_bf16 v[208:223], v[88:91], v[108:111], v[208:223]
    v_mfma_f32_32x32x16_bf16 v[224:239], v[92:95], v[104:107], v[224:239]
    v_mfma_f32_32x32x16_bf16 v[240:255], v[92:95], v[108:111], v[240:255]
    s_waitcnt lgkmcnt(0)
    v_mfma_f32_32x32x16_bf16 v[128:143], v[64:67], v[96:99], v[128:143]
    ds_read_b128 v[104:107], v9 offset:16384
    ds_read_b64_tr_b16 v[80:81], v12 offset:20480
    s_waitcnt vmcnt(0)
    v_lshlrev_b32 v42, 16, v24
    v_and_b32 v43, 0xffff0000, v24
    v_mfma_f32_32x32x16_bf16 v[144:159], v[64:67], v[100:103], v[144:159]
    ds_read_b64_tr_b16 v[82:83], v12 offset:21504
    ds_read_b128 v[108:111], v9 offset:20480
    v_add_f32 v36, v42, v43
    v_mul_f32 v39, v42, v42
    v_fmac_f32 v39, v43, v43
    v_mfma_f32_32x32x16_bf16 v[160:175], v[68:71], v[96:99], v[160:175]
    ds_read_b64_tr_b16 v[84:85], v13 offset:20480
    ds_read_b64_tr_b16 v[86:87], v13 offset:21504
    v_lshlrev_b32 v42, 16, v25
    v_and_b32 v43, 0xffff0000, v25
    v_add_f32 v36, v36, v42
    v_mfma_f32_32x32x16_bf16 v[176:191], v[68:71], v[100:103], v[176:191]
    ds_read_b64_tr_b16 v[88:89], v14 offset:20480
    ds_read_b64_tr_b16 v[90:91], v14 offset:21504
    v_fmac_f32 v39, v42, v42
    v_add_f32 v36, v36, v43
    v_fmac_f32 v39, v43, v43
    v_mfma_f32_32x32x16_bf16 v[192:207], v[72:75], v[96:99], v[192:207]
    ds_read_b64_tr_b16 v[92:93], v15 offset:20480
    ds_read_b64_tr_b16 v[94:95], v15 offset:21504
    v_lshlrev_b32 v42, 16, v26
    v_and_b32 v43, 0xffff0000, v26
    v_add_f32 v36, v36, v42
    v_mfma_f32_32x32x16_bf16 v[208:223], v[72:75], v[100:103], v[208:223]
    v_fmac_f32 v39, v42, v42
    v_add_f32 v36, v36, v43
    v_fmac_f32 v39, v43, v43
    v_mfma_f32_32x32x16_bf16 v[224:239], v[76:79], v[96:99], v[224:239]
    v_lshlrev_b32 v42, 16, v27
    v_and_b32 v43, 0xffff0000, v27
    v_add_f32 v36, v36, v42
    v_mfma_f32_32x32x16_bf16 v[240:255], v[76:79], v[100:103], v[240:255]
    v_fmac_f32 v39, v42, v42
    v_add_f32 v36, v36, v43
    v_fmac_f32 v39, v43, v43
    s_waitcnt lgkmcnt(0)
    v_mfma_f32_32x32x16_bf16 v[128:143], v[80:83], v[104:107], v[128:143]
    ds_read_b128 v[96:99], v10 offset:16384
    ds_read_b64_tr_b16 v[64:65], v12 offset:24576
    v_lshlrev_b32 v42, 16, v28
    v_and_b32 v43, 0xffff0000, v28
    v_add_f32 v37, v42, v43
    v_mfma_f32_32x32x16_bf16 v[144:159], v[80:83], v[108:111], v[144:159]
    ds_read_b64_tr_b16 v[66:67], v12 offset:25600
    ds_read_b128 v[100:103], v10 offset:20480
    v_mul_f32 v40, v42, v42
    v_fmac_f32 v40, v43, v43
    v_lshlrev_b32 v42, 16, v29
    v_mfma_f32_32x32x16_bf16 v[160:175], v[84:87], v[104:107], v[160:175]
    ds_read_b64_tr_b16 v[68:69], v13 offset:24576
    ds_read_b64_tr_b16 v[70:71], v13 offset:25600
    v_and_b32 v43, 0xffff0000, v29
    v_add_f32 v37, v37, v42
    v_fmac_f32 v40, v42, v42
    v_mfma_f32_32x32x16_bf16 v[176:191], v[84:87], v[108:111], v[176:191]
    ds_read_b64_tr_b16 v[72:73], v14 offset:24576
    ds_read_b64_tr_b16 v[74:75], v14 offset:25600
    v_add_f32 v37, v37, v43
    v_fmac_f32 v40, v43, v43
    v_lshlrev_b32 v42, 16, v30
    v_mfma_f32_32x32x16_bf16 v[192:207], v[88:91], v[104:107], v[192:207]
    ds_read_b64_tr_b16 v[76:77], v15 offset:24576
    ds_read_b64_tr_b16 v[78:79], v15 offset:25600
    v_and_b32 v43, 0xffff0000, v30
    v_add_f32 v37, v37, v42
    v_fmac_f32 v40, v42, v42
    v_mfma_f32_32x32x16_bf16 v[208:223], v[88:91], v[108:111], v[208:223]
    v_add_f32 v37, v37, v43
    v_fmac_f32 v40, v43, v43
    v_lshlrev_b32 v42, 16, v31
    v_mfma_f32_32x32x16_bf16 v[224:239], v[92:95], v[104:107], v[224:239]
    v_and_b32 v43, 0xffff0000, v31
    v_add_f32 v37, v37, v42
    v_fmac_f32 v40, v42, v42
    v_mfma_f32_32x32x16_bf16 v[240:255], v[92:95], v[108:111], v[240:255]
    v_add_f32 v37, v37, v43
    v_fmac_f32 v40, v43, v43
    v_lshlrev_b32 v42, 16, v32
    s_waitcnt lgkmcnt(0)
    v_mfma_f32_32x32x16_bf16 v[128:143], v[64:67], v[96:99], v[128:143]
    ds_read_b128 v[104:107], v11 offset:16384
    ds_read_b64_tr_b16 v[80:81], v12 offset:28672
    v_and_b32 v43, 0xffff0000, v32
    v_add_f32 v38, v42, v43
    v_mul_f32 v41, v42, v42
    v_mfma_f32_32x32x16_bf16 v[144:159], v[64:67], v[100:103], v[144:159]
    ds_read_b64_tr_b16 v[82:83], v12 offset:29696
    ds_read_b128 v[108:111], v11 offset:20480
    v_fmac_f32 v41, v43, v43
    v_lshlrev_b32 v42, 16, v33
    v_and_b32 v43, 0xffff0000, v33
    v_mfma_f32_32x32x16_bf16 v[160:175], v[68:71], v[96:99], v[160:175]
    ds_read_b64_tr_b16 v[84:85], v13 offset:28672
    ds_read_b64_tr_b16 v[86:87], v13 offset:29696
    v_add_f32 v38, v38, v42
    v_fmac_f32 v41, v42, v42
    v_add_f32 v38, v38, v43
    v_mfma_f32_32x32x16_bf16 v[176:191], v[68:71], v[100:103], v[176:191]
    ds_read_b64_tr_b16 v[88:89], v14 offset:28672
    ds_read_b64_tr_b16 v[90:91], v14 offset:29696
    v_fmac_f32 v41, v43, v43
    v_lshlrev_b32 v42, 16, v34
    v_and_b32 v43, 0xffff0000, v34
    v_mfma_f32_32x32x16_bf16 v[192:207], v[72:75], v[96:99], v[192:207]
    ds_read_b64_tr_b16 v[92:93], v15 offset:28672
    ds_read_b64_tr_b16 v[94:95], v15 offset:29696
    v_add_f32 v38, v38, v42
    v_fmac_f32 v41, v42, v42
    v_add_f32 v38, v38, v43
    v_mfma_f32_32x32x16_bf16 v[208:223], v[72:75], v[100:103], v[208:223]
    v_fmac_f32 v41, v43, v43
    v_lshlrev_b32 v42, 16, v35
    v_and_b32 v43, 0xffff0000, v35
    v_mfma_f32_32x32x16_bf16 v[224:239], v[76:79], v[96:99], v[224:239]
    v_add_f32 v38, v38, v42
    v_fmac_f32 v41, v42, v42
    v_add_f32 v38, v38, v43
    v_mfma_f32_32x32x16_bf16 v[240:255], v[76:79], v[100:103], v[240:255]
    v_fmac_f32 v41, v43, v43
    s_nop 0
    v_add_f32_dpp v36, v36, v36 row_shr:1 row_mask:0xf bank_mask:0xf
    s_waitcnt lgkmcnt(0)
    s_barrier
    v_mfma_f32_32x32x16_bf16 v[128:143], v[80:83], v[104:107], v[128:143]
    ds_read_b128 v[96:99], v8 offset:32768
    ds_read_b64_tr_b16 v[64:65], v12 offset:32768
    v_add_f32_dpp v37, v37, v37 row_shr:1 row_mask:0xf bank_mask:0xf
    v_add_f32_dpp v38, v38, v38 row_shr:1 row_mask:0xf bank_mask:0xf
    v_add_f32_dpp v39, v39, v39 row_shr:1 row_mask:0xf bank_mask:0xf
    v_mfma_f32_32x32x16_bf16 v[144:159], v[80:83], v[108:111], v[144:159]
    ds_read_b64_tr_b16 v[66:67], v12 offset:33792
    ds_read_b128 v[100:103], v8 offset:36864
    v_add_f32_dpp v40, v40, v40 row_shr:1 row_mask:0xf bank_mask:0xf
    v_add_f32_dpp v41, v41, v41 row_shr:1 row_mask:0xf bank_mask:0xf
    v_add_f32_dpp v36, v36, v36 row_shr:2 row_mask:0xf bank_mask:0xf
    v_mfma_f32_32x32x16_bf16 v[160:175], v[84:87], v[104:107], v[160:175]
    ds_read_b64_tr_b16 v[68:69], v13 offset:32768
    ds_read_b64_tr_b16 v[70:71], v13 offset:33792
    v_add_f32_dpp v37, v37, v37 row_shr:2 row_mask:0xf bank_mask:0xf
    v_add_f32_dpp v38, v38, v38 row_shr:2 row_mask:0xf bank_mask:0xf
    v_add_f32_dpp v39, v39, v39 row_shr:2 row_mask:0xf bank_mask:0xf
    v_mfma_f32_32x32x16_bf16 v[176:191], v[84:87], v[108:111], v[176:191]
    ds_read_b64_tr_b16 v[72:73], v14 offset:32768
    ds_read_b64_tr_b16 v[74:75], v14 offset:33792
    v_add_f32_dpp v40, v40, v40 row_shr:2 row_mask:0xf bank_mask:0xf
    v_add_f32_dpp v41, v41, v41 row_shr:2 row_mask:0xf bank_mask:0xf
    v_add_f32_dpp v36, v36, v36 row_shr:4 row_mask:0xf bank_mask:0xf
    v_mfma_f32_32x32x16_bf16 v[192:207], v[88:91], v[104:107], v[192:207]
    ds_read_b64_tr_b16 v[76:77], v15 offset:32768
    ds_read_b64_tr_b16 v[78:79], v15 offset:33792
    v_add_f32_dpp v37, v37, v37 row_shr:4 row_mask:0xf bank_mask:0xf
    v_add_f32_dpp v38, v38, v38 row_shr:4 row_mask:0xf bank_mask:0xf
    v_add_f32_dpp v39, v39, v39 row_shr:4 row_mask:0xf bank_mask:0xf
    v_mfma_f32_32x32x16_bf16 v[208:223], v[88:91], v[108:111], v[208:223]
    v_add_f32_dpp v40, v40, v40 row_shr:4 row_mask:0xf bank_mask:0xf
    v_add_f32_dpp v41, v41, v41 row_shr:4 row_mask:0xf bank_mask:0xf
    v_add_f32_dpp v36, v36, v36 row_shr:8 row_mask:0xf bank_mask:0xf
    v_mfma_f32_32x32x16_bf16 v[224:239], v[92:95], v[104:107], v[224:239]
    v_add_f32_dpp v37, v37, v37 row_shr:8 row_mask:0xf bank_mask:0xf
    v_add_f32_dpp v38, v38, v38 row_shr:8 row_mask:0xf bank_mask:0xf
    v_add_f32_dpp v39, v39, v39 row_shr:8 row_mask:0xf bank_mask:0xf
    v_mfma_f32_32x32x16_bf16 v[240:255], v[92:95], v[108:111], v[240:255]
    v_add_f32_dpp v40, v40, v40 row_shr:8 row_mask:0xf bank_mask:0xf
    v_add_f32_dpp v41, v41, v41 row_shr:8 row_mask:0xf bank_mask:0xf
    v_add_f32_dpp v36, v36, v36 row_bcast:15 row_mask:0xa bank_mask:0xf
    s_waitcnt lgkmcnt(0)
    v_mfma_f32_32x32x16_bf16 v[128:143], v[64:67], v[96:99], v[128:143]
    ds_read_b128 v[104:107], v9 offset:32768
    ds_read_b64_tr_b16 v[80:81], v12 offset:36864
    v_add_f32_dpp v37, v37, v37 row_bcast:15 row_mask:0xa bank_mask:0xf
    v_add_f32_dpp v38, v38, v38 row_bcast:15 row_mask:0xa bank_mask:0xf
    v_add_f32_dpp v39, v39, v39 row_bcast:15 row_mask:0xa bank_mask:0xf
    v_mfma_f32_32x32x16_bf16 v[144:159], v[64:67], v[100:103], v[144:159]
    ds_read_b64_tr_b16 v[82:83], v12 offset:37888
    ds_read_b128 v[108:111], v9 offset:36864
    v_add_f32_dpp v40, v40, v40 row_bcast:15 row_mask:0xa bank_mask:0xf
    v_add_f32_dpp v41, v41, v41 row_bcast:15 row_mask:0xa bank_mask:0xf
    v_add_f32_dpp v36, v36, v36 row_bcast:31 row_mask:0xc bank_mask:0xf
    v_mfma_f32_32x32x16_bf16 v[160:175], v[68:71], v[96:99], v[160:175]
    ds_read_b64_tr_b16 v[84:85], v13 offset:36864
    ds_read_b64_tr_b16 v[86:87], v13 offset:37888
    v_add_f32_dpp v37, v37, v37 row_bcast:31 row_mask:0xc bank_mask:0xf
    v_add_f32_dpp v38, v38, v38 row_bcast:31 row_mask:0xc bank_mask:0xf
    v_add_f32_dpp v39, v39, v39 row_bcast:31 row_mask:0xc bank_mask:0xf
    v_mfma_f32_32x32x16_bf16 v[176:191], v[68:71], v[100:103], v[176:191]
    ds_read_b64_tr_b16 v[88:89], v14 offset:36864
    ds_read_b64_tr_b16 v[90:91], v14 offset:37888
    v_add_f32_dpp v40, v40, v40 row_bcast:31 row_mask:0xc bank_mask:0xf
    v_add_f32_dpp v41, v41, v41 row_bcast:31 row_mask:0xc bank_mask:0xf
    v_mul_f32 v44, 0.002232142857142857, v36
    v_mfma_f32_32x32x16_bf16 v[192:207], v[72:75], v[96:99], v[192:207]
    ds_read_b64_tr_b16 v[92:93], v15 offset:36864
    ds_read_b64_tr_b16 v[94:95], v15 offset:37888
    v_mul_f32 v39, 0.002232142857142857, v39
    v_fma_f32 v39, -v44, v44, v39
    v_max_f32 v39, 0, v39
    v_mfma_f32_32x32x16_bf16 v[208:223], v[72:75], v[100:103], v[208:223]
    v_add_f32 v39, 0x3727c5ac, v39
    v_rsq_f32 v45, v39
    v_mul_f32 v46, 0.002232142857142857, v37
    v_mfma_f32_32x32x16_bf16 v[224:239], v[76:79], v[96:99], v[224:239]
    v_mul_f32 v40, 0.002232142857142857, v40
    v_fma_f32 v40, -v46, v46, v40
    v_max_f32 v40, 0, v40
    v_mfma_f32_32x32x16_bf16 v[240:255], v[76:79], v[100:103], v[240:255]
    v_add_f32 v40, 0x3727c5ac, v40
    v_rsq_f32 v47, v40
    v_mul_f32 v48, 0.002232142857142857, v38
    s_waitcnt lgkmcnt(0)
    v_mfma_f32_32x32x16_bf16 v[128:143], v[80:83], v[104:107], v[128:143]
    ds_read_b128 v[96:99], v10 offset:32768
    ds_read_b64_tr_b16 v[64:65], v12 offset:40960
    v_mul_f32 v41, 0.002232142857142857, v41
    v_fma_f32 v41, -v48, v48, v41
    v_max_f32 v41, 0, v41
    v_mfma_f32_32x32x16_bf16 v[144:159], v[80:83], v[108:111], v[144:159]
    ds_read_b64_tr_b16 v[66:67], v12 offset:41984
    ds_read_b128 v[100:103], v10 offset:36864
    v_add_f32 v41, 0x3727c5ac, v41
    v_rsq_f32 v49, v41
    v_mfma_f32_32x32x16_bf16 v[160:175], v[84:87], v[104:107], v[160:175]
    ds_read_b64_tr_b16 v[68:69], v13 offset:40960
    ds_read_b64_tr_b16 v[70:71], v13 offset:41984
    s_mov_b32 exec_lo, 0
    s_mov_b32 exec_hi, 0x80000000
    ds_write_b64 v50, v[44:45] offset:0
    ds_write_b64 v50, v[46:47] offset:32
    ds_write_b64 v50, v[48:49] offset:64
    s_mov_b64 exec, -1
    s_nop 3
    v_mfma_f32_32x32x16_bf16 v[176:191], v[84:87], v[108:111], v[176:191]
    ds_read_b64_tr_b16 v[72:73], v14 offset:40960
    ds_read_b64_tr_b16 v[74:75], v14 offset:41984
    v_mfma_f32_32x32x16_bf16 v[192:207], v[88:91], v[104:107], v[192:207]
    ds_read_b64_tr_b16 v[76:77], v15 offset:40960
    ds_read_b64_tr_b16 v[78:79], v15 offset:41984
    v_mfma_f32_32x32x16_bf16 v[208:223], v[88:91], v[108:111], v[208:223]
    v_mfma_f32_32x32x16_bf16 v[224:239], v[92:95], v[104:107], v[224:239]
    v_mfma_f32_32x32x16_bf16 v[240:255], v[92:95], v[108:111], v[240:255]
    s_waitcnt lgkmcnt(0)
    v_mfma_f32_32x32x16_bf16 v[128:143], v[64:67], v[96:99], v[128:143]
    ds_read_b128 v[104:107], v11 offset:32768
    ds_read_b64_tr_b16 v[80:81], v12 offset:45056
    v_mfma_f32_32x32x16_bf16 v[144:159], v[64:67], v[100:103], v[144:159]
    ds_read_b64_tr_b16 v[82:83], v12 offset:46080
    ds_read_b128 v[108:111], v11 offset:36864
    v_mfma_f32_32x32x16_bf16 v[160:175], v[68:71], v[96:99], v[160:175]
    ds_read_b64_tr_b16 v[84:85], v13 offset:45056
    ds_read_b64_tr_b16 v[86:87], v13 offset:46080
    v_mfma_f32_32x32x16_bf16 v[176:191], v[68:71], v[100:103], v[176:191]
    ds_read_b64_tr_b16 v[88:89], v14 offset:45056
    ds_read_b64_tr_b16 v[90:91], v14 offset:46080
    v_mfma_f32_32x32x16_bf16 v[192:207], v[72:75], v[96:99], v[192:207]
    ds_read_b64_tr_b16 v[92:93], v15 offset:45056
    ds_read_b64_tr_b16 v[94:95], v15 offset:46080
    v_mfma_f32_32x32x16_bf16 v[208:223], v[72:75], v[100:103], v[208:223]
    v_mfma_f32_32x32x16_bf16 v[224:239], v[76:79], v[96:99], v[224:239]
    v_mfma_f32_32x32x16_bf16 v[240:255], v[76:79], v[100:103], v[240:255]
    s_waitcnt lgkmcnt(0)
    s_barrier
    v_mfma_f32_32x32x16_bf16 v[128:143], v[80:83], v[104:107], v[128:143]
    ds_read_b128 v[96:99], v8 offset:0
    ds_read_b64_tr_b16 v[64:65], v12 offset:0
    v_mfma_f32_32x32x16_bf16 v[144:159], v[80:83], v[108:111], v[144:159]
    ds_read_b64_tr_b16 v[66:67], v12 offset:1024
    ds_read_b128 v[100:103], v8 offset:4096
    v_mfma_f32_32x32x16_bf16 v[160:175], v[84:87], v[104:107], v[160:175]
    ds_read_b64_tr_b16 v[68:69], v13 offset:0
    ds_read_b64_tr_b16 v[70:71], v13 offset:1024
    v_mfma_f32_32x32x16_bf16 v[176:191], v[84:87], v[108:111], v[176:191]
    ds_read_b64_tr_b16 v[72:73], v14 offset:0
    ds_read_b64_tr_b16 v[74:75], v14 offset:1024
    v_mfma_f32_32x32x16_bf16 v[192:207], v[88:91], v[104:107], v[192:207]
    ds_read_b64_tr_b16 v[76:77], v15 offset:0
    ds_read_b64_tr_b16 v[78:79], v15 offset:1024
    v_mfma_f32_32x32x16_bf16 v[208:223], v[88:91], v[108:111], v[208:223]
    v_mfma_f32_32x32x16_bf16 v[224:239], v[92:95], v[104:107], v[224:239]
    v_mfma_f32_32x32x16_bf16 v[240:255], v[92:95], v[108:111], v[240:255]
    s_waitcnt lgkmcnt(0)
    v_mfma_f32_32x32x16_bf16 v[128:143], v[64:67], v[96:99], v[128:143]
    ds_read_b128 v[104:107], v9 offset:0
    ds_read_b64_tr_b16 v[80:81], v12 offset:4096
    v_mfma_f32_32x32x16_bf16 v[144:159], v[64:67], v[100:103], v[144:159]
    ds_read_b64_tr_b16 v[82:83], v12 offset:5120
    ds_read_b128 v[108:111], v9 offset:4096
    v_mfma_f32_32x32x16_bf16 v[160:175], v[68:71], v[96:99], v[160:175]
    ds_read_b64_tr_b16 v[84:85], v13 offset:4096
    ds_read_b64_tr_b16 v[86:87], v13 offset:5120
    v_mfma_f32_32x32x16_bf16 v[176:191], v[68:71], v[100:103], v[176:191]
    ds_read_b64_tr_b16 v[88:89], v14 offset:4096
    ds_read_b64_tr_b16 v[90:91], v14 offset:5120
    v_mfma_f32_32x32x16_bf16 v[192:207], v[72:75], v[96:99], v[192:207]
    ds_read_b64_tr_b16 v[92:93], v15 offset:4096
    ds_read_b64_tr_b16 v[94:95], v15 offset:5120
    v_mfma_f32_32x32x16_bf16 v[208:223], v[72:75], v[100:103], v[208:223]
    v_mfma_f32_32x32x16_bf16 v[224:239], v[76:79], v[96:99], v[224:239]
    v_mfma_f32_32x32x16_bf16 v[240:255], v[76:79], v[100:103], v[240:255]
    s_waitcnt lgkmcnt(0)
    v_mfma_f32_32x32x16_bf16 v[128:143], v[80:83], v[104:107], v[128:143]
    ds_read_b128 v[96:99], v10 offset:0
    ds_read_b64_tr_b16 v[64:65], v12 offset:8192
    v_mfma_f32_32x32x16_bf16 v[144:159], v[80:83], v[108:111], v[144:159]
    ds_read_b64_tr_b16 v[66:67], v12 offset:9216
    ds_read_b128 v[100:103], v10 offset:4096
    v_mfma_f32_32x32x16_bf16 v[160:175], v[84:87], v[104:107], v[160:175]
    ds_read_b64_tr_b16 v[68:69], v13 offset:8192
    ds_read_b64_tr_b16 v[70:71], v13 offset:9216
    v_mfma_f32_32x32x16_bf16 v[176:191], v[84:87], v[108:111], v[176:191]
    ds_read_b64_tr_b16 v[72:73], v14 offset:8192
    ds_read_b64_tr_b16 v[74:75], v14 offset:9216
    v_mfma_f32_32x32x16_bf16 v[192:207], v[88:91], v[104:107], v[192:207]
    ds_read_b64_tr_b16 v[76:77], v15 offset:8192
    ds_read_b64_tr_b16 v[78:79], v15 offset:9216
    v_mfma_f32_32x32x16_bf16 v[208:223], v[88:91], v[108:111], v[208:223]
    v_mfma_f32_32x32x16_bf16 v[224:239], v[92:95], v[104:107], v[224:239]
    v_mfma_f32_32x32x16_bf16 v[240:255], v[92:95], v[108:111], v[240:255]
    s_waitcnt lgkmcnt(0)
    v_mfma_f32_32x32x16_bf16 v[128:143], v[64:67], v[96:99], v[128:143]
    ds_read_b128 v[104:107], v11 offset:0
    ds_read_b64_tr_b16 v[80:81], v12 offset:12288
    v_mfma_f32_32x32x16_bf16 v[144:159], v[64:67], v[100:103], v[144:159]
    ds_read_b64_tr_b16 v[82:83], v12 offset:13312
    ds_read_b128 v[108:111], v11 offset:4096
    v_mfma_f32_32x32x16_bf16 v[160:175], v[68:71], v[96:99], v[160:175]
    ds_read_b64_tr_b16 v[84:85], v13 offset:12288
    ds_read_b64_tr_b16 v[86:87], v13 offset:13312
    v_mfma_f32_32x32x16_bf16 v[176:191], v[68:71], v[100:103], v[176:191]
    ds_read_b64_tr_b16 v[88:89], v14 offset:12288
    ds_read_b64_tr_b16 v[90:91], v14 offset:13312
    v_mfma_f32_32x32x16_bf16 v[192:207], v[72:75], v[96:99], v[192:207]
    ds_read_b64_tr_b16 v[92:93], v15 offset:12288
    ds_read_b64_tr_b16 v[94:95], v15 offset:13312
    v_mfma_f32_32x32x16_bf16 v[208:223], v[72:75], v[100:103], v[208:223]
    v_mfma_f32_32x32x16_bf16 v[224:239], v[76:79], v[96:99], v[224:239]
    v_mfma_f32_32x32x16_bf16 v[240:255], v[76:79], v[100:103], v[240:255]
    s_waitcnt lgkmcnt(0)
    s_barrier
    v_mfma_f32_32x32x16_bf16 v[128:143], v[80:83], v[104:107], v[128:143]
    ds_read_b128 v[96:99], v8 offset:16384
    ds_read_b64_tr_b16 v[64:65], v12 offset:16384
    v_mfma_f32_32x32x16_bf16 v[144:159], v[80:83], v[108:111], v[144:159]
    ds_read_b64_tr_b16 v[66:67], v12 offset:17408
    ds_read_b128 v[100:103], v8 offset:20480
    v_mfma_f32_32x32x16_bf16 v[160:175], v[84:87], v[104:107], v[160:175]
    ds_read_b64_tr_b16 v[68:69], v13 offset:16384
    ds_read_b64_tr_b16 v[70:71], v13 offset:17408
    v_mfma_f32_32x32x16_bf16 v[176:191], v[84:87], v[108:111], v[176:191]
    ds_read_b64_tr_b16 v[72:73], v14 offset:16384
    ds_read_b64_tr_b16 v[74:75], v14 offset:17408
    v_mfma_f32_32x32x16_bf16 v[192:207], v[88:91], v[104:107], v[192:207]
    ds_read_b64_tr_b16 v[76:77], v15 offset:16384
    ds_read_b64_tr_b16 v[78:79], v15 offset:17408
    v_mfma_f32_32x32x16_bf16 v[208:223], v[88:91], v[108:111], v[208:223]
    v_mfma_f32_32x32x16_bf16 v[224:239], v[92:95], v[104:107], v[224:239]
    v_mfma_f32_32x32x16_bf16 v[240:255], v[92:95], v[108:111], v[240:255]
    s_waitcnt lgkmcnt(0)
    v_mfma_f32_32x32x16_bf16 v[128:143], v[64:67], v[96:99], v[128:143]
    ds_read_b128 v[104:107], v9 offset:16384
    ds_read_b64_tr_b16 v[80:81], v12 offset:20480
    v_mfma_f32_32x32x16_bf16 v[144:159], v[64:67], v[100:103], v[144:159]
    ds_read_b64_tr_b16 v[82:83], v12 offset:21504
    ds_read_b128 v[108:111], v9 offset:20480
    v_mfma_f32_32x32x16_bf16 v[160:175], v[68:71], v[96:99], v[160:175]
    ds_read_b64_tr_b16 v[84:85], v13 offset:20480
    ds_read_b64_tr_b16 v[86:87], v13 offset:21504
    v_mfma_f32_32x32x16_bf16 v[176:191], v[68:71], v[100:103], v[176:191]
    ds_read_b64_tr_b16 v[88:89], v14 offset:20480
    ds_read_b64_tr_b16 v[90:91], v14 offset:21504
    v_mfma_f32_32x32x16_bf16 v[192:207], v[72:75], v[96:99], v[192:207]
    ds_read_b64_tr_b16 v[92:93], v15 offset:20480
    ds_read_b64_tr_b16 v[94:95], v15 offset:21504
    v_mfma_f32_32x32x16_bf16 v[208:223], v[72:75], v[100:103], v[208:223]
    v_mfma_f32_32x32x16_bf16 v[224:239], v[76:79], v[96:99], v[224:239]
    v_mfma_f32_32x32x16_bf16 v[240:255], v[76:79], v[100:103], v[240:255]
    s_waitcnt lgkmcnt(0)
    v_mfma_f32_32x32x16_bf16 v[128:143], v[80:83], v[104:107], v[128:143]
    ds_read_b128 v[96:99], v10 offset:16384
    ds_read_b64_tr_b16 v[64:65], v12 offset:24576
    v_mfma_f32_32x32x16_bf16 v[144:159], v[80:83], v[108:111], v[144:159]
    ds_read_b64_tr_b16 v[66:67], v12 offset:25600
    ds_read_b128 v[100:103], v10 offset:20480
    v_mfma_f32_32x32x16_bf16 v[160:175], v[84:87], v[104:107], v[160:175]
    ds_read_b64_tr_b16 v[68:69], v13 offset:24576
    ds_read_b64_tr_b16 v[70:71], v13 offset:25600
    v_mfma_f32_32x32x16_bf16 v[176:191], v[84:87], v[108:111], v[176:191]
    ds_read_b64_tr_b16 v[72:73], v14 offset:24576
    ds_read_b64_tr_b16 v[74:75], v14 offset:25600
    v_mfma_f32_32x32x16_bf16 v[192:207], v[88:91], v[104:107], v[192:207]
    ds_read_b64_tr_b16 v[76:77], v15 offset:24576
    ds_read_b64_tr_b16 v[78:79], v15 offset:25600
    v_mfma_f32_32x32x16_bf16 v[208:223], v[88:91], v[108:111], v[208:223]
    v_mfma_f32_32x32x16_bf16 v[224:239], v[92:95], v[104:107], v[224:239]
    v_mfma_f32_32x32x16_bf16 v[240:255], v[92:95], v[108:111], v[240:255]
    s_waitcnt lgkmcnt(0)
    v_mfma_f32_32x32x16_bf16 v[128:143], v[64:67], v[96:99], v[128:143]
    ds_read_b128 v[104:107], v11 offset:16384
    ds_read_b64_tr_b16 v[80:81], v12 offset:28672
    v_mfma_f32_32x32x16_bf16 v[144:159], v[64:67], v[100:103], v[144:159]
    ds_read_b64_tr_b16 v[82:83], v12 offset:29696
    ds_read_b128 v[108:111], v11 offset:20480
    v_mfma_f32_32x32x16_bf16 v[160:175], v[68:71], v[96:99], v[160:175]
    ds_read_b64_tr_b16 v[84:85], v13 offset:28672
    ds_read_b64_tr_b16 v[86:87], v13 offset:29696
    v_mfma_f32_32x32x16_bf16 v[176:191], v[68:71], v[100:103], v[176:191]
    ds_read_b64_tr_b16 v[88:89], v14 offset:28672
    ds_read_b64_tr_b16 v[90:91], v14 offset:29696
    v_mfma_f32_32x32x16_bf16 v[192:207], v[72:75], v[96:99], v[192:207]
    ds_read_b64_tr_b16 v[92:93], v15 offset:28672
    ds_read_b64_tr_b16 v[94:95], v15 offset:29696
    v_mfma_f32_32x32x16_bf16 v[208:223], v[72:75], v[100:103], v[208:223]
    v_mfma_f32_32x32x16_bf16 v[224:239], v[76:79], v[96:99], v[224:239]
    v_mfma_f32_32x32x16_bf16 v[240:255], v[76:79], v[100:103], v[240:255]
    s_waitcnt lgkmcnt(0)
    s_barrier
    v_mfma_f32_32x32x16_bf16 v[128:143], v[80:83], v[104:107], v[128:143]
    ds_read_b128 v[96:99], v8 offset:32768
    ds_read_b64_tr_b16 v[64:65], v12 offset:32768
    v_mfma_f32_32x32x16_bf16 v[144:159], v[80:83], v[108:111], v[144:159]
    ds_read_b64_tr_b16 v[66:67], v12 offset:33792
    ds_read_b128 v[100:103], v8 offset:36864
    v_mfma_f32_32x32x16_bf16 v[160:175], v[84:87], v[104:107], v[160:175]
    ds_read_b64_tr_b16 v[68:69], v13 offset:32768
    ds_read_b64_tr_b16 v[70:71], v13 offset:33792
    v_mfma_f32_32x32x16_bf16 v[176:191], v[84:87], v[108:111], v[176:191]
    ds_read_b64_tr_b16 v[72:73], v14 offset:32768
    ds_read_b64_tr_b16 v[74:75], v14 offset:33792
    v_mfma_f32_32x32x16_bf16 v[192:207], v[88:91], v[104:107], v[192:207]
    ds_read_b64_tr_b16 v[76:77], v15 offset:32768
    ds_read_b64_tr_b16 v[78:79], v15 offset:33792
    v_mfma_f32_32x32x16_bf16 v[208:223], v[88:91], v[108:111], v[208:223]
    v_mfma_f32_32x32x16_bf16 v[224:239], v[92:95], v[104:107], v[224:239]
    v_mfma_f32_32x32x16_bf16 v[240:255], v[92:95], v[108:111], v[240:255]
    s_waitcnt lgkmcnt(0)
    v_mfma_f32_32x32x16_bf16 v[128:143], v[64:67], v[96:99], v[128:143]
    ds_read_b128 v[104:107], v9 offset:32768
    ds_read_b64_tr_b16 v[80:81], v12 offset:36864
    v_mfma_f32_32x32x16_bf16 v[144:159], v[64:67], v[100:103], v[144:159]
    ds_read_b64_tr_b16 v[82:83], v12 offset:37888
    ds_read_b128 v[108:111], v9 offset:36864
    v_mfma_f32_32x32x16_bf16 v[160:175], v[68:71], v[96:99], v[160:175]
    ds_read_b64_tr_b16 v[84:85], v13 offset:36864
    ds_read_b64_tr_b16 v[86:87], v13 offset:37888
    v_mfma_f32_32x32x16_bf16 v[176:191], v[68:71], v[100:103], v[176:191]
    ds_read_b64_tr_b16 v[88:89], v14 offset:36864
    ds_read_b64_tr_b16 v[90:91], v14 offset:37888
    v_mfma_f32_32x32x16_bf16 v[192:207], v[72:75], v[96:99], v[192:207]
    ds_read_b64_tr_b16 v[92:93], v15 offset:36864
    ds_read_b64_tr_b16 v[94:95], v15 offset:37888
    v_mfma_f32_32x32x16_bf16 v[208:223], v[72:75], v[100:103], v[208:223]
    v_mfma_f32_32x32x16_bf16 v[224:239], v[76:79], v[96:99], v[224:239]
    v_mfma_f32_32x32x16_bf16 v[240:255], v[76:79], v[100:103], v[240:255]
    s_waitcnt lgkmcnt(0)
    v_mfma_f32_32x32x16_bf16 v[128:143], v[80:83], v[104:107], v[128:143]
    ds_read_b128 v[96:99], v10 offset:32768
    ds_read_b64_tr_b16 v[64:65], v12 offset:40960
    v_mfma_f32_32x32x16_bf16 v[144:159], v[80:83], v[108:111], v[144:159]
    ds_read_b64_tr_b16 v[66:67], v12 offset:41984
    ds_read_b128 v[100:103], v10 offset:36864
    v_mfma_f32_32x32x16_bf16 v[160:175], v[84:87], v[104:107], v[160:175]
    ds_read_b64_tr_b16 v[68:69], v13 offset:40960
    ds_read_b64_tr_b16 v[70:71], v13 offset:41984
    v_mfma_f32_32x32x16_bf16 v[176:191], v[84:87], v[108:111], v[176:191]
    ds_read_b64_tr_b16 v[72:73], v14 offset:40960
    ds_read_b64_tr_b16 v[74:75], v14 offset:41984
    v_mfma_f32_32x32x16_bf16 v[192:207], v[88:91], v[104:107], v[192:207]
    ds_read_b64_tr_b16 v[76:77], v15 offset:40960
    ds_read_b64_tr_b16 v[78:79], v15 offset:41984
    v_mfma_f32_32x32x16_bf16 v[208:223], v[88:91], v[108:111], v[208:223]
    v_mfma_f32_32x32x16_bf16 v[224:239], v[92:95], v[104:107], v[224:239]
    v_mfma_f32_32x32x16_bf16 v[240:255], v[92:95], v[108:111], v[240:255]
    s_waitcnt lgkmcnt(0)
    v_mfma_f32_32x32x16_bf16 v[128:143], v[64:67], v[96:99], v[128:143]
    ds_read_b128 v[104:107], v11 offset:32768
    ds_read_b64_tr_b16 v[80:81], v12 offset:45056
    v_mfma_f32_32x32x16_bf16 v[144:159], v[64:67], v[100:103], v[144:159]
    ds_read_b64_tr_b16 v[82:83], v12 offset:46080
    ds_read_b128 v[108:111], v11 offset:36864
    v_mfma_f32_32x32x16_bf16 v[160:175], v[68:71], v[96:99], v[160:175]
    ds_read_b64_tr_b16 v[84:85], v13 offset:45056
    ds_read_b64_tr_b16 v[86:87], v13 offset:46080
    v_mfma_f32_32x32x16_bf16 v[176:191], v[68:71], v[100:103], v[176:191]
    ds_read_b64_tr_b16 v[88:89], v14 offset:45056
    ds_read_b64_tr_b16 v[90:91], v14 offset:46080
    v_mfma_f32_32x32x16_bf16 v[192:207], v[72:75], v[96:99], v[192:207]
    ds_read_b64_tr_b16 v[92:93], v15 offset:45056
    ds_read_b64_tr_b16 v[94:95], v15 offset:46080
    v_mfma_f32_32x32x16_bf16 v[208:223], v[72:75], v[100:103], v[208:223]
    v_mfma_f32_32x32x16_bf16 v[224:239], v[76:79], v[96:99], v[224:239]
    v_mfma_f32_32x32x16_bf16 v[240:255], v[76:79], v[100:103], v[240:255]
    s_waitcnt lgkmcnt(0)
    s_barrier
    v_mfma_f32_32x32x16_bf16 v[128:143], v[80:83], v[104:107], v[128:143]
    ds_read_b128 v[96:99], v8 offset:0
    ds_read_b64_tr_b16 v[64:65], v12 offset:0
    v_mfma_f32_32x32x16_bf16 v[144:159], v[80:83], v[108:111], v[144:159]
    ds_read_b64_tr_b16 v[66:67], v12 offset:1024
    ds_read_b128 v[100:103], v8 offset:4096
    v_mfma_f32_32x32x16_bf16 v[160:175], v[84:87], v[104:107], v[160:175]
    ds_read_b64_tr_b16 v[68:69], v13 offset:0
    ds_read_b64_tr_b16 v[70:71], v13 offset:1024
    v_mfma_f32_32x32x16_bf16 v[176:191], v[84:87], v[108:111], v[176:191]
    ds_read_b64_tr_b16 v[72:73], v14 offset:0
    ds_read_b64_tr_b16 v[74:75], v14 offset:1024
    v_mfma_f32_32x32x16_bf16 v[192:207], v[88:91], v[104:107], v[192:207]
    ds_read_b64_tr_b16 v[76:77], v15 offset:0
    ds_read_b64_tr_b16 v[78:79], v15 offset:1024
    v_mfma_f32_32x32x16_bf16 v[208:223], v[88:91], v[108:111], v[208:223]
    v_mfma_f32_32x32x16_bf16 v[224:239], v[92:95], v[104:107], v[224:239]
    v_mfma_f32_32x32x16_bf16 v[240:255], v[92:95], v[108:111], v[240:255]
    s_waitcnt lgkmcnt(0)
    v_mfma_f32_32x32x16_bf16 v[128:143], v[64:67], v[96:99], v[128:143]
    ds_read_b128 v[104:107], v9 offset:0
    ds_read_b64_tr_b16 v[80:81], v12 offset:4096
    v_mfma_f32_32x32x16_bf16 v[144:159], v[64:67], v[100:103], v[144:159]
    ds_read_b64_tr_b16 v[82:83], v12 offset:5120
    ds_read_b128 v[108:111], v9 offset:4096
    v_mfma_f32_32x32x16_bf16 v[160:175], v[68:71], v[96:99], v[160:175]
    ds_read_b64_tr_b16 v[84:85], v13 offset:4096
    ds_read_b64_tr_b16 v[86:87], v13 offset:5120
    v_mfma_f32_32x32x16_bf16 v[176:191], v[68:71], v[100:103], v[176:191]
    ds_read_b64_tr_b16 v[88:89], v14 offset:4096
    ds_read_b64_tr_b16 v[90:91], v14 offset:5120
    v_mfma_f32_32x32x16_bf16 v[192:207], v[72:75], v[96:99], v[192:207]
    ds_read_b64_tr_b16 v[92:93], v15 offset:4096
    ds_read_b64_tr_b16 v[94:95], v15 offset:5120
    v_mfma_f32_32x32x16_bf16 v[208:223], v[72:75], v[100:103], v[208:223]
    v_mfma_f32_32x32x16_bf16 v[224:239], v[76:79], v[96:99], v[224:239]
    v_mfma_f32_32x32x16_bf16 v[240:255], v[76:79], v[100:103], v[240:255]
    s_waitcnt lgkmcnt(0)
    v_mfma_f32_32x32x16_bf16 v[128:143], v[80:83], v[104:107], v[128:143]
    ds_read_b128 v[96:99], v10 offset:0
    ds_read_b64_tr_b16 v[64:65], v12 offset:8192
    v_mfma_f32_32x32x16_bf16 v[144:159], v[80:83], v[108:111], v[144:159]
    ds_read_b64_tr_b16 v[66:67], v12 offset:9216
    ds_read_b128 v[100:103], v10 offset:4096
    v_mfma_f32_32x32x16_bf16 v[160:175], v[84:87], v[104:107], v[160:175]
    ds_read_b64_tr_b16 v[68:69], v13 offset:8192
    ds_read_b64_tr_b16 v[70:71], v13 offset:9216
    v_mfma_f32_32x32x16_bf16 v[176:191], v[84:87], v[108:111], v[176:191]
    ds_read_b64_tr_b16 v[72:73], v14 offset:8192
    ds_read_b64_tr_b16 v[74:75], v14 offset:9216
    v_mfma_f32_32x32x16_bf16 v[192:207], v[88:91], v[104:107], v[192:207]
    ds_read_b64_tr_b16 v[76:77], v15 offset:8192
    ds_read_b64_tr_b16 v[78:79], v15 offset:9216
    v_mfma_f32_32x32x16_bf16 v[208:223], v[88:91], v[108:111], v[208:223]
    v_mfma_f32_32x32x16_bf16 v[224:239], v[92:95], v[104:107], v[224:239]
    v_mfma_f32_32x32x16_bf16 v[240:255], v[92:95], v[108:111], v[240:255]
    s_waitcnt lgkmcnt(0)
    v_mfma_f32_32x32x16_bf16 v[128:143], v[64:67], v[96:99], v[128:143]
    ds_read_b128 v[104:107], v11 offset:0
    ds_read_b64_tr_b16 v[80:81], v12 offset:12288
    v_mfma_f32_32x32x16_bf16 v[144:159], v[64:67], v[100:103], v[144:159]
    ds_read_b64_tr_b16 v[82:83], v12 offset:13312
    ds_read_b128 v[108:111], v11 offset:4096
    v_mfma_f32_32x32x16_bf16 v[160:175], v[68:71], v[96:99], v[160:175]
    ds_read_b64_tr_b16 v[84:85], v13 offset:12288
    ds_read_b64_tr_b16 v[86:87], v13 offset:13312
    v_mfma_f32_32x32x16_bf16 v[176:191], v[68:71], v[100:103], v[176:191]
    ds_read_b64_tr_b16 v[88:89], v14 offset:12288
    ds_read_b64_tr_b16 v[90:91], v14 offset:13312
    v_mfma_f32_32x32x16_bf16 v[192:207], v[72:75], v[96:99], v[192:207]
    ds_read_b64_tr_b16 v[92:93], v15 offset:12288
    ds_read_b64_tr_b16 v[94:95], v15 offset:13312
    v_mfma_f32_32x32x16_bf16 v[208:223], v[72:75], v[100:103], v[208:223]
    v_mfma_f32_32x32x16_bf16 v[224:239], v[76:79], v[96:99], v[224:239]
    v_mfma_f32_32x32x16_bf16 v[240:255], v[76:79], v[100:103], v[240:255]
    s_waitcnt lgkmcnt(0)
    s_barrier
    v_mfma_f32_32x32x16_bf16 v[128:143], v[80:83], v[104:107], v[128:143]
    ds_read_b64 v[96:97], v18
    v_mov_b32 v98, 0
    v_mfma_f32_32x32x16_bf16 v[144:159], v[80:83], v[108:111], v[144:159]
    v_mov_b32 v99, 0
    ds_read_b64 v[100:101], v20
    v_mfma_f32_32x32x16_bf16 v[160:175], v[84:87], v[104:107], v[160:175]
    v_mov_b32 v102, 0
    v_mov_b32 v103, 0
    v_mfma_f32_32x32x16_bf16 v[176:191], v[84:87], v[108:111], v[176:191]
    ds_read_b64 v[64:65], v19 offset:0
    v_mov_b32 v66, 0
    v_mfma_f32_32x32x16_bf16 v[192:207], v[88:91], v[104:107], v[192:207]
    v_mov_b32 v67, 0
    ds_read_b64 v[68:69], v19 offset:256
    v_mfma_f32_32x32x16_bf16 v[208:223], v[88:91], v[108:111], v[208:223]
    v_mov_b32 v70, 0
    v_mov_b32 v71, 0
    v_mfma_f32_32x32x16_bf16 v[224:239], v[92:95], v[104:107], v[224:239]
    ds_read_b64 v[72:73], v19 offset:512
    v_mov_b32 v74, 0
    v_mfma_f32_32x32x16_bf16 v[240:255], v[92:95], v[108:111], v[240:255]
    v_mov_b32 v75, 0
    ds_read_b64 v[76:77], v19 offset:768
    v_mov_b32 v78, 0
    v_mov_b32 v79, 0
    s_waitcnt lgkmcnt(0)
    v_mfma_f32_32x32x16_bf16 v[128:143], v[64:67], v[96:99], v[128:143]
    v_mfma_f32_32x32x16_bf16 v[144:159], v[64:67], v[100:103], v[144:159]
    v_mfma_f32_32x32x16_bf16 v[160:175], v[68:71], v[96:99], v[160:175]
    v_mfma_f32_32x32x16_bf16 v[176:191], v[68:71], v[100:103], v[176:191]
    v_mfma_f32_32x32x16_bf16 v[192:207], v[72:75], v[96:99], v[192:207]
    v_mfma_f32_32x32x16_bf16 v[208:223], v[72:75], v[100:103], v[208:223]
    v_mfma_f32_32x32x16_bf16 v[224:239], v[76:79], v[96:99], v[224:239]
    v_mfma_f32_32x32x16_bf16 v[240:255], v[76:79], v[100:103], v[240:255]
    v_mov_b32 v4, 162816
    ds_read_b64 v[20:21], v4
    s_lshl_b32 s58, s52, 2
    s_lshl_b32 s59, s62, 1
    s_add_u32 s58, s58, s59
    s_mul_i32 s58, s58, 112
    s_lshl_b32 s59, s53, 3
    s_add_u32 s58, s58, s59
    s_lshl_b32 s59, s63, 2
    s_add_u32 s58, s58, s59
    s_lshl_b32 s64, s58, 10
    s_waitcnt lgkmcnt(0)
    v_readfirstlane_b32 s31, v20
    v_readfirstlane_b32 s99, v21
    v_lshrrev_b32 v4, 3, v0
    v_and_b32 v5, 7, v0
    v_bfe_u32 v6, v0, 4, 1
    v_lshlrev_b32 v6, 2, v6
    v_xor_b32 v5, v5, v6
    v_mul_u32_u24 v4, 896, v4
    v_lshl_add_u32 v21, v5, 4, v4
    s_mul_i32 s65, s30, 401408
    s_lshl_b32 s58, s55, 7
    s_add_u32 s65, s65, s58
    s_mul_i32 s66, s30, 30720
    v_max_f32 v128, 0, v128
    v_max_f32 v129, 0, v129
    v_max_f32 v130, 0, v130
    v_max_f32 v131, 0, v131
    v_max_f32 v132, 0, v132
    v_max_f32 v133, 0, v133
    v_max_f32 v134, 0, v134
    v_max_f32 v135, 0, v135
    v_mul_f32 v128, v128, v136
    v_mul_f32 v129, v129, v137
    v_mul_f32 v130, v130, v138
    v_mul_f32 v131, v131, v139
    v_mul_f32 v132, v132, v140
    v_mul_f32 v133, v133, v141
    v_mul_f32 v134, v134, v142
    v_mul_f32 v135, v135, v143
    v_cvt_pk_bf16_f32 v24, v128, v129
    v_cvt_pk_bf16_f32 v25, v130, v131
    v_cvt_pk_bf16_f32 v26, v132, v133
    v_cvt_pk_bf16_f32 v27, v134, v135
    s_add_u32 s58, s64, 0
    buffer_store_dwordx4 v[24:27], v17, s[44:47], s58 offen sc1
    v_max_f32 v144, 0, v144
    v_max_f32 v145, 0, v145
    v_max_f32 v146, 0, v146
    v_max_f32 v147, 0, v147
    v_max_f32 v148, 0, v148
    v_max_f32 v149, 0, v149
    v_max_f32 v150, 0, v150
    v_max_f32 v151, 0, v151
    v_mul_f32 v144, v144, v152
    v_mul_f32 v145, v145, v153
    v_mul_f32 v146, v146, v154
    v_mul_f32 v147, v147, v155
    v_mul_f32 v148, v148, v156
    v_mul_f32 v149, v149, v157
    v_mul_f32 v150, v150, v158
    v_mul_f32 v151, v151, v159
    v_cvt_pk_bf16_f32 v28, v144, v145
    v_cvt_pk_bf16_f32 v29, v146, v147
    v_cvt_pk_bf16_f32 v30, v148, v149
    v_cvt_pk_bf16_f32 v31, v150, v151
    s_add_u32 s58, s64, 114688
    buffer_store_dwordx4 v[28:31], v17, s[44:47], s58 offen sc1
    v_max_f32 v160, 0, v160
    v_max_f32 v161, 0, v161
    v_max_f32 v162, 0, v162
    v_max_f32 v163, 0, v163
    v_max_f32 v164, 0, v164
    v_max_f32 v165, 0, v165
    v_max_f32 v166, 0, v166
    v_max_f32 v167, 0, v167
    v_mul_f32 v160, v160, v168
    v_mul_f32 v161, v161, v169
    v_mul_f32 v162, v162, v170
    v_mul_f32 v163, v163, v171
    v_mul_f32 v164, v164, v172
    v_mul_f32 v165, v165, v173
    v_mul_f32 v166, v166, v174
    v_mul_f32 v167, v167, v175
    v_cvt_pk_bf16_f32 v32, v160, v161
    v_cvt_pk_bf16_f32 v33, v162, v163
    v_cvt_pk_bf16_f32 v34, v164, v165
    v_cvt_pk_bf16_f32 v35, v166, v167
    s_add_u32 s58, s64, 1024
    buffer_store_dwordx4 v[32:35], v17, s[44:47], s58 offen sc1
    s_add_u32 m0, s66, 0
    s_add_u32 s59, s65, 215040
    buffer_load_dwordx4 v21, s[32:35], s59 offen lds
    s_add_u32 m0, s66, 1024
    s_add_u32 s59, s65, 222208
    buffer_load_dwordx4 v21, s[32:35], s59 offen lds
    s_add_u32 m0, s66, 2048
    s_add_u32 s59, s65, 229376
    buffer_load_dwordx4 v21, s[32:35], s59 offen lds
    s_add_u32 m0, s66, 3072
    s_add_u32 s59, s65, 236544
    buffer_load_dwordx4 v21, s[32:35], s59 offen lds
    v_max_f32 v176, 0, v176
    v_max_f32 v177, 0, v177
    v_max_f32 v178, 0, v178
    v_max_f32 v179, 0, v179
    v_max_f32 v180, 0, v180
    v_max_f32 v181, 0, v181
    v_max_f32 v182, 0, v182
    v_max_f32 v183, 0, v183
    v_mul_f32 v176, v176, v184
    v_mul_f32 v177, v177, v185
    v_mul_f32 v178, v178, v186
    v_mul_f32 v179, v179, v187
    v_mul_f32 v180, v180, v188
    v_mul_f32 v181, v181, v189
    v_mul_f32 v182, v182, v190
    v_mul_f32 v183, v183, v191
    v_cvt_pk_bf16_f32 v36, v176, v177
    v_cvt_pk_bf16_f32 v37, v178, v179
    v_cvt_pk_bf16_f32 v38, v180, v181
    v_cvt_pk_bf16_f32 v39, v182, v183
    s_add_u32 s58, s64, 115712
    buffer_store_dwordx4 v[36:39], v17, s[44:47], s58 offen sc1
    s_add_u32 m0, s66, 4096
    s_add_u32 s59, s65, 243712
    buffer_load_dwordx4 v21, s[32:35], s59 offen lds
    s_add_u32 m0, s66, 5120
    s_add_u32 s59, s65, 250880
    buffer_load_dwordx4 v21, s[32:35], s59 offen lds
    s_add_u32 m0, s66, 6144
    s_add_u32 s59, s65, 258048
    buffer_load_dwordx4 v21, s[32:35], s59 offen lds
    s_add_u32 m0, s66, 7168
    s_add_u32 s59, s65, 265216
    buffer_load_dwordx4 v21, s[32:35], s59 offen lds
    v_max_f32 v192, 0, v192
    v_max_f32 v193, 0, v193
    v_max_f32 v194, 0, v194
    v_max_f32 v195, 0, v195
    v_max_f32 v196, 0, v196
    v_max_f32 v197, 0, v197
    v_max_f32 v198, 0, v198
    v_max_f32 v199, 0, v199
    v_mul_f32 v192, v192, v200
    v_mul_f32 v193, v193, v201
    v_mul_f32 v194, v194, v202
    v_mul_f32 v195, v195, v203
    v_mul_f32 v196, v196, v204
    v_mul_f32 v197, v197, v205
    v_mul_f32 v198, v198, v206
    v_mul_f32 v199, v199, v207
    v_cvt_pk_bf16_f32 v24, v192, v193
    v_cvt_pk_bf16_f32 v25, v194, v195
    v_cvt_pk_bf16_f32 v26, v196, v197
    v_cvt_pk_bf16_f32 v27, v198, v199
    s_add_u32 s58, s64, 2048
    buffer_store_dwordx4 v[24:27], v17, s[44:47], s58 offen sc1
    s_add_u32 m0, s66, 8192
    s_add_u32 s59, s65, 272384
    buffer_load_dwordx4 v21, s[32:35], s59 offen lds
    s_add_u32 m0, s66, 9216
    s_add_u32 s59, s65, 279552
    buffer_load_dwordx4 v21, s[32:35], s59 offen lds
    s_add_u32 m0, s66, 10240
    s_add_u32 s59, s65, 286720
    buffer_load_dwordx4 v21, s[32:35], s59 offen lds
    s_add_u32 m0, s66, 11264
    s_add_u32 s59, s65, 293888
    buffer_load_dwordx4 v21, s[32:35], s59 offen lds
    v_max_f32 v208, 0, v208
    v_max_f32 v209, 0, v209
    v_max_f32 v210, 0, v210
    v_max_f32 v211, 0, v211
    v_max_f32 v212, 0, v212
    v_max_f32 v213, 0, v213
    v_max_f32 v214, 0, v214
    v_max_f32 v215, 0, v215
    v_mul_f32 v208, v208, v216
    v_mul_f32 v209, v209, v217
    v_mul_f32 v210, v210, v218
    v_mul_f32 v211, v211, v219
    v_mul_f32 v212, v212, v220
    v_mul_f32 v213, v213, v221
    v_mul_f32 v214, v214, v222
    v_mul_f32 v215, v215, v223
    v_cvt_pk_bf16_f32 v28, v208, v209
    v_cvt_pk_bf16_f32 v29, v210, v211
    v_cvt_pk_bf16_f32 v30, v212, v213
    v_cvt_pk_bf16_f32 v31, v214, v215
    s_add_u32 s58, s64, 116736
    buffer_store_dwordx4 v[28:31], v17, s[44:47], s58 offen sc1
    s_add_u32 m0, s66, 12288
    s_add_u32 s59, s65, 301056
    buffer_load_dwordx4 v21, s[32:35], s59 offen lds
    s_add_u32 m0, s66, 13312
    s_add_u32 s59, s65, 308224
    buffer_load_dwordx4 v21, s[32:35], s59 offen lds
    s_add_u32 m0, s66, 14336
    s_add_u32 s59, s65, 315392
    buffer_load_dwordx4 v21, s[32:35], s59 offen lds
    s_add_u32 m0, s66, 15360
    s_add_u32 s59, s65, 322560
    buffer_load_dwordx4 v21, s[32:35], s59 offen lds
    v_max_f32 v224, 0, v224
    v_max_f32 v225, 0, v225
    v_max_f32 v226, 0, v226
    v_max_f32 v227, 0, v227
    v_max_f32 v228, 0, v228
    v_max_f32 v229, 0, v229
    v_max_f32 v230, 0, v230
    v_max_f32 v231, 0, v231
    v_mul_f32 v224, v224, v232
    v_mul_f32 v225, v225, v233
    v_mul_f32 v226, v226, v234
    v_mul_f32 v227, v227, v235
    v_mul_f32 v228, v228, v236
    v_mul_f32 v229, v229, v237
    v_mul_f32 v230, v230, v238
    v_mul_f32 v231, v231, v239
    v_cvt_pk_bf16_f32 v32, v224, v225
    v_cvt_pk_bf16_f32 v33, v226, v227
    v_cvt_pk_bf16_f32 v34, v228, v229
    v_cvt_pk_bf16_f32 v35, v230, v231
    s_add_u32 s58, s64, 3072
    buffer_store_dwordx4 v[32:35], v17, s[44:47], s58 offen sc1
    s_add_u32 m0, s66, 16384
    s_add_u32 s59, s65, 329728
    buffer_load_dwordx4 v21, s[32:35], s59 offen lds
    s_add_u32 m0, s66, 17408
    s_add_u32 s59, s65, 336896
    buffer_load_dwordx4 v21, s[32:35], s59 offen lds
    s_add_u32 m0, s66, 18432
    s_add_u32 s59, s65, 344064
    buffer_load_dwordx4 v21, s[32:35], s59 offen lds
    s_add_u32 m0, s66, 19456
    s_add_u32 s59, s65, 351232
    buffer_load_dwordx4 v21, s[32:35], s59 offen lds
    v_max_f32 v240, 0, v240
    v_max_f32 v241, 0, v241
    v_max_f32 v242, 0, v242
    v_max_f32 v243, 0, v243
    v_max_f32 v244, 0, v244
    v_max_f32 v245, 0, v245
    v_max_f32 v246, 0, v246
    v_max_f32 v247, 0, v247
    v_mul_f32 v240, v240, v248
    v_mul_f32 v241, v241, v249
    v_mul_f32 v242, v242, v250
    v_mul_f32 v243, v243, v251
    v_mul_f32 v244, v244, v252
    v_mul_f32 v245, v245, v253
    v_mul_f32 v246, v246, v254
    v_mul_f32 v247, v247, v255
    v_cvt_pk_bf16_f32 v36, v240, v241
    v_cvt_pk_bf16_f32 v37, v242, v243
    v_cvt_pk_bf16_f32 v38, v244, v245
    v_cvt_pk_bf16_f32 v39, v246, v247
    s_add_u32 s58, s64, 117760
    buffer_store_dwordx4 v[36:39], v17, s[44:47], s58 offen sc1
    s_add_u32 m0, s66, 20480
    s_add_u32 s59, s65, 358400
    buffer_load_dwordx4 v21, s[32:35], s59 offen lds
    s_add_u32 m0, s66, 21504
    s_add_u32 s59, s65, 365568
    buffer_load_dwordx4 v21, s[32:35], s59 offen lds
    s_add_u32 m0, s66, 22528
    s_add_u32 s59, s65, 372736
    buffer_load_dwordx4 v21, s[32:35], s59 offen lds
    s_add_u32 m0, s66, 23552
    s_add_u32 s59, s65, 379904
    buffer_load_dwordx4 v21, s[32:35], s59 offen lds
    s_add_u32 m0, s66, 24576
    s_add_u32 s59, s65, 387072
    buffer_load_dwordx4 v21, s[32:35], s59 offen lds
    s_add_u32 m0, s66, 25600
    s_add_u32 s59, s65, 394240
    buffer_load_dwordx4 v21, s[32:35], s59 offen lds
    s_add_u32 m0, s66, 26624
    s_add_u32 s59, s65, 186368
    buffer_load_dwordx4 v21, s[32:35], s59 offen lds
    s_add_u32 m0, s66, 27648
    s_add_u32 s59, s65, 193536
    buffer_load_dwordx4 v21, s[32:35], s59 offen lds
    s_add_u32 m0, s66, 28672
    s_add_u32 s59, s65, 200704
    buffer_load_dwordx4 v21, s[32:35], s59 offen lds
    s_add_u32 m0, s66, 29696
    s_add_u32 s59, s65, 207872
    buffer_load_dwordx4 v21, s[32:35], s59 offen lds
    s_lshl_b32 s58, s52, 1
    s_add_u32 s58, s58, s62
    s_mul_i32 s58, s58, 28
    s_lshl_b32 s59, s53, 1
    s_add_u32 s58, s58, s59
    s_add_u32 s58, s58, s63
    s_lshl_b32 s58, s58, 7
    s_add_u32 s59, s58, 11141120
    s_waitcnt vmcnt(0)
    v_mov_b32 v4, s31
    v_mov_b32 v5, 0
    s_mov_b64 exec, 1
    buffer_store_dword v4, v5, s[44:47], s59 offen sc1
    s_mov_b64 exec, -1
    v_bfe_u32 v4, v0, 2, 2
    v_lshrrev_b32 v5, 5, v0
    v_lshl_add_u32 v5, v5, 2, v4
    v_lshlrev_b32 v5, 7, v5
    v_and_b32 v6, 1, v0
    v_lshl_add_u32 v5, v6, 3, v5
    v_add_u32 v5, s66, v5
    v_bfe_u32 v6, v0, 4, 1
    v_bfe_u32 v7, v0, 1, 1
    v_lshl_add_u32 v6, v6, 1, v7
    v_bfe_u32 v7, v0, 3, 1
    v_lshl_add_u32 v6, v7, 2, v6
    v_lshl_add_u32 v22, v6, 4, v5
    v_xor_b32 v6, 4, v6
    v_lshl_add_u32 v23, v6, 4, v5
    ds_read_b64_tr_b16 v[88:89], v22 offset:0
    ds_read_b64_tr_b16 v[90:91], v22 offset:1024
    ds_read_b64_tr_b16 v[92:93], v23 offset:0
    ds_read_b64_tr_b16 v[94:95], v23 offset:1024
    ds_read_b64_tr_b16 v[96:97], v22 offset:2048
    ds_read_b64_tr_b16 v[98:99], v22 offset:3072
    ds_read_b64_tr_b16 v[100:101], v23 offset:2048
    ds_read_b64_tr_b16 v[102:103], v23 offset:3072
    ds_read_b64_tr_b16 v[104:105], v22 offset:4096
    ds_read_b64_tr_b16 v[106:107], v22 offset:5120
    ds_read_b64_tr_b16 v[108:109], v23 offset:4096
    ds_read_b64_tr_b16 v[110:111], v23 offset:5120
    s_waitcnt lgkmcnt(4)
    ds_read_b64_tr_b16 v[112:113], v22 offset:6144
    ds_read_b64_tr_b16 v[114:115], v22 offset:7168
    ds_read_b64_tr_b16 v[116:117], v23 offset:6144
    ds_read_b64_tr_b16 v[118:119], v23 offset:7168
    ds_read_b64_tr_b16 v[120:121], v22 offset:8192
    ds_read_b64_tr_b16 v[122:123], v22 offset:9216
    ds_read_b64_tr_b16 v[124:125], v23 offset:8192
    ds_read_b64_tr_b16 v[126:127], v23 offset:9216
    ds_read_b64_tr_b16 v[128:129], v22 offset:10240
    ds_read_b64_tr_b16 v[130:131], v22 offset:11264
    ds_read_b64_tr_b16 v[132:133], v23 offset:10240
    ds_read_b64_tr_b16 v[134:135], v23 offset:11264
    s_waitcnt lgkmcnt(4)
    ds_read_b64_tr_b16 v[136:137], v22 offset:12288
    ds_read_b64_tr_b16 v[138:139], v22 offset:13312
    ds_read_b64_tr_b16 v[140:141], v23 offset:12288
    ds_read_b64_tr_b16 v[142:143], v23 offset:13312
    ds_read_b64_tr_b16 v[144:145], v22 offset:14336
    ds_read_b64_tr_b16 v[146:147], v22 offset:15360
    ds_read_b64_tr_b16 v[148:149], v23 offset:14336
    ds_read_b64_tr_b16 v[150:151], v23 offset:15360
    ds_read_b64_tr_b16 v[152:153], v22 offset:16384
    ds_read_b64_tr_b16 v[154:155], v22 offset:17408
    ds_read_b64_tr_b16 v[156:157], v23 offset:16384
    ds_read_b64_tr_b16 v[158:159], v23 offset:17408
    s_waitcnt lgkmcnt(4)
    ds_read_b64_tr_b16 v[160:161], v22 offset:18432
    ds_read_b64_tr_b16 v[162:163], v22 offset:19456
    ds_read_b64_tr_b16 v[164:165], v23 offset:18432
    ds_read_b64_tr_b16 v[166:167], v23 offset:19456
    ds_read_b64_tr_b16 v[168:169], v22 offset:20480
    ds_read_b64_tr_b16 v[170:171], v22 offset:21504
    ds_read_b64_tr_b16 v[172:173], v23 offset:20480
    ds_read_b64_tr_b16 v[174:175], v23 offset:21504
    ds_read_b64_tr_b16 v[176:177], v22 offset:22528
    ds_read_b64_tr_b16 v[178:179], v22 offset:23552
    ds_read_b64_tr_b16 v[180:181], v23 offset:22528
    ds_read_b64_tr_b16 v[182:183], v23 offset:23552
    s_waitcnt lgkmcnt(4)
    ds_read_b64_tr_b16 v[184:185], v22 offset:24576
    ds_read_b64_tr_b16 v[186:187], v22 offset:25600
    ds_read_b64_tr_b16 v[188:189], v23 offset:24576
    ds_read_b64_tr_b16 v[190:191], v23 offset:25600
    s_waitcnt lgkmcnt(0)
    s_mul_i32 s58, s56, 28
    s_mul_i32 s59, s30, 7
    s_add_u32 s58, s58, s59
    s_lshl_b32 s58, s58, 7
    s_add_u32 s58, s58, 11141120
    v_min_u32 v16, 6, v0
    v_lshlrev_b32 v16, 7, v16
    v_add_u32 v16, s58, v16
    s_add_u32 m0, s66, 0
    s_add_u32 s59, s65, 0
    buffer_load_dwordx4 v21, s[32:35], s59 offen lds
    s_add_u32 m0, s66, 1024
    s_add_u32 s59, s65, 7168
    buffer_load_dwordx4 v21, s[32:35], s59 offen lds
    s_add_u32 m0, s66, 2048
    s_add_u32 s59, s65, 14336
    buffer_load_dwordx4 v21, s[32:35], s59 offen lds
    s_add_u32 m0, s66, 3072
    s_add_u32 s59, s65, 21504
    buffer_load_dwordx4 v21, s[32:35], s59 offen lds
    s_add_u32 m0, s66, 4096
    s_add_u32 s59, s65, 28672
    buffer_load_dwordx4 v21, s[32:35], s59 offen lds
    s_add_u32 m0, s66, 5120
    s_add_u32 s59, s65, 35840
    buffer_load_dwordx4 v21, s[32:35], s59 offen lds
    s_add_u32 m0, s66, 6144
    s_add_u32 s59, s65, 43008
    buffer_load_dwordx4 v21, s[32:35], s59 offen lds
    s_add_u32 m0, s66, 7168
    s_add_u32 s59, s65, 50176
    buffer_load_dwordx4 v21, s[32:35], s59 offen lds
    s_add_u32 m0, s66, 8192
    s_add_u32 s59, s65, 57344
    buffer_load_dwordx4 v21, s[32:35], s59 offen lds
    s_add_u32 m0, s66, 9216
    s_add_u32 s59, s65, 64512
    buffer_load_dwordx4 v21, s[32:35], s59 offen lds
    s_add_u32 m0, s66, 10240
    s_add_u32 s59, s65, 71680
    buffer_load_dwordx4 v21, s[32:35], s59 offen lds
    s_add_u32 m0, s66, 11264
    s_add_u32 s59, s65, 78848
    buffer_load_dwordx4 v21, s[32:35], s59 offen lds
    s_add_u32 m0, s66, 12288
    s_add_u32 s59, s65, 86016
    buffer_load_dwordx4 v21, s[32:35], s59 offen lds
    s_add_u32 m0, s66, 13312
    s_add_u32 s59, s65, 93184
    buffer_load_dwordx4 v21, s[32:35], s59 offen lds
    buffer_load_dword v6, v16, s[44:47], 0 offen sc1
    s_add_u32 m0, s66, 14336
    s_add_u32 s59, s65, 100352
    buffer_load_dwordx4 v21, s[32:35], s59 offen lds
    s_add_u32 m0, s66, 15360
    s_add_u32 s59, s65, 107520
    buffer_load_dwordx4 v21, s[32:35], s59 offen lds
    s_add_u32 m0, s66, 16384
    s_add_u32 s59, s65, 114688
    buffer_load_dwordx4 v21, s[32:35], s59 offen lds
    s_add_u32 m0, s66, 17408
    s_add_u32 s59, s65, 121856
    buffer_load_dwordx4 v21, s[32:35], s59 offen lds
    s_add_u32 m0, s66, 18432
    s_add_u32 s59, s65, 129024
    buffer_load_dwordx4 v21, s[32:35], s59 offen lds
    s_add_u32 m0, s66, 19456
    s_add_u32 s59, s65, 136192
    buffer_load_dwordx4 v21, s[32:35], s59 offen lds
    s_add_u32 m0, s66, 20480
    s_add_u32 s59, s65, 143360
    buffer_load_dwordx4 v21, s[32:35], s59 offen lds
    s_add_u32 m0, s66, 21504
    s_add_u32 s59, s65, 150528
    buffer_load_dwordx4 v21, s[32:35], s59 offen lds
    s_add_u32 m0, s66, 22528
    s_add_u32 s59, s65, 157696
    buffer_load_dwordx4 v21, s[32:35], s59 offen lds
    s_add_u32 m0, s66, 23552
    s_add_u32 s59, s65, 164864
    buffer_load_dwordx4 v21, s[32:35], s59 offen lds
    s_add_u32 m0, s66, 24576
    s_add_u32 s59, s65, 172032
    buffer_load_dwordx4 v21, s[32:35], s59 offen lds
    s_add_u32 m0, s66, 25600
    s_add_u32 s59, s65, 179200
    buffer_load_dwordx4 v21, s[32:35], s59 offen lds
    s_waitcnt vmcnt(12)
    v_cmp_ne_u32 vcc, s31, v6
    s_nop 1
    s_cbranch_vccz L_f1ok_22
    s_mov_b32 s68, 65536
L_poll_23:
    buffer_load_dword v4, v16, s[44:47], 0 offen sc1
    s_waitcnt vmcnt(0)
    v_cmp_ne_u32 vcc, s31, v4
    s_nop 1
    s_cbranch_vccz L_polled_24
    s_sleep 1
    s_sub_u32 s68, s68, 1
    s_cmp_lg_u32 s68, 0
    s_cbranch_scc1 L_poll_23
L_polled_24:
L_f1ok_22:
    s_mul_i32 s64, s56, 224
    s_mul_i32 s58, s30, 28
    s_add_u32 s64, s64, s58
    s_lshl_b32 s64, s64, 10
    s_add_u32 s58, s64, 15360
    buffer_load_dwordx4 v[40:43], v17, s[44:47], s58 offen sc1
    s_add_u32 s58, s64, 130048
    buffer_load_dwordx4 v[44:47], v17, s[44:47], s58 offen sc1
    s_add_u32 s58, s64, 16384
    buffer_load_dwordx4 v[48:51], v17, s[44:47], s58 offen sc1
    s_add_u32 s58, s64, 131072
    buffer_load_dwordx4 v[52:55], v17, s[44:47], s58 offen sc1
    s_add_u32 s58, s64, 17408
    buffer_load_dwordx4 v[56:59], v17, s[44:47], s58 offen sc1
    s_add_u32 s58, s64, 132096
    buffer_load_dwordx4 v[60:63], v17, s[44:47], s58 offen sc1
    s_add_u32 s58, s64, 18432
    buffer_load_dwordx4 v[64:67], v17, s[44:47], s58 offen sc1
    s_add_u32 s58, s64, 133120
    buffer_load_dwordx4 v[68:71], v17, s[44:47], s58 offen sc1
    s_add_u32 s58, s64, 19456
    buffer_load_dwordx4 v[72:75], v17, s[44:47], s58 offen sc1
    s_add_u32 s58, s64, 134144
    buffer_load_dwordx4 v[76:79], v17, s[44:47], s58 offen sc1
    s_add_u32 s58, s64, 20480
    buffer_load_dwordx4 v[80:83], v17, s[44:47], s58 offen sc1
    s_add_u32 s58, s64, 135168
    buffer_load_dwordx4 v[84:87], v17, s[44:47], s58 offen sc1
    s_waitcnt vmcnt(10)
    v_mfma_f32_32x32x16_bf16 v[192:207], v[88:91], v[40:43], 0
    v_mfma_f32_32x32x16_bf16 v[208:223], v[88:91], v[44:47], 0
    v_mfma_f32_32x32x16_bf16 v[224:239], v[92:95], v[40:43], 0
    v_mfma_f32_32x32x16_bf16 v[240:255], v[92:95], v[44:47], 0
    s_add_u32 s58, s64, 21504
    buffer_load_dwordx4 v[40:43], v17, s[44:47], s58 offen sc1
    s_add_u32 s58, s64, 136192
    buffer_load_dwordx4 v[44:47], v17, s[44:47], s58 offen sc1
    s_waitcnt vmcnt(10)
    v_mfma_f32_32x32x16_bf16 v[192:207], v[96:99], v[48:51], v[192:207]
    v_mfma_f32_32x32x16_bf16 v[208:223], v[96:99], v[52:55], v[208:223]
    v_mfma_f32_32x32x16_bf16 v[224:239], v[100:103], v[48:51], v[224:239]
    v_mfma_f32_32x32x16_bf16 v[240:255], v[100:103], v[52:55], v[240:255]
    s_add_u32 s58, s64, 22528
    buffer_load_dwordx4 v[48:51], v17, s[44:47], s58 offen sc1
    s_add_u32 s58, s64, 137216
    buffer_load_dwordx4 v[52:55], v17, s[44:47], s58 offen sc1
    s_waitcnt vmcnt(10)
    v_mfma_f32_32x32x16_bf16 v[192:207], v[104:107], v[56:59], v[192:207]
    v_mfma_f32_32x32x16_bf16 v[208:223], v[104:107], v[60:63], v[208:223]
    v_mfma_f32_32x32x16_bf16 v[224:239], v[108:111], v[56:59], v[224:239]
    v_mfma_f32_32x32x16_bf16 v[240:255], v[108:111], v[60:63], v[240:255]
    s_add_u32 s58, s64, 23552
    buffer_load_dwordx4 v[56:59], v17, s[44:47], s58 offen sc1
    s_add_u32 s58, s64, 138240
    buffer_load_dwordx4 v[60:63], v17, s[44:47], s58 offen sc1
    s_waitcnt vmcnt(10)
    v_mfma_f32_32x32x16_bf16 v[192:207], v[112:115], v[64:67], v[192:207]
    v_mfma_f32_32x32x16_bf16 v[208:223], v[112:115], v[68:71], v[208:223]
    v_mfma_f32_32x32x16_bf16 v[224:239], v[116:119], v[64:67], v[224:239]
    v_mfma_f32_32x32x16_bf16 v[240:255], v[116:119], v[68:71], v[240:255]
    s_add_u32 s58, s64, 24576
    buffer_load_dwordx4 v[64:67], v17, s[44:47], s58 offen sc1
    s_add_u32 s58, s64, 139264
    buffer_load_dwordx4 v[68:71], v17, s[44:47], s58 offen sc1
    s_waitcnt vmcnt(10)
    v_mfma_f32_32x32x16_bf16 v[192:207], v[120:123], v[72:75], v[192:207]
    v_mfma_f32_32x32x16_bf16 v[208:223], v[120:123], v[76:79], v[208:223]
    v_mfma_f32_32x32x16_bf16 v[224:239], v[124:127], v[72:75], v[224:239]
    v_mfma_f32_32x32x16_bf16 v[240:255], v[124:127], v[76:79], v[240:255]
    v_mov_b32 v4, 162956
    v_mov_b32 v5, 1
    s_mov_b64 exec, 1
    ds_add_u32 v4, v5
    s_mov_b64 exec, -1
    s_add_u32 s58, s64, 25600
    buffer_load_dwordx4 v[72:75], v17, s[44:47], s58 offen sc1
    s_add_u32 s58, s64, 140288
    buffer_load_dwordx4 v[76:79], v17, s[44:47], s58 offen sc1
    s_waitcnt vmcnt(10)
    v_mfma_f32_32x32x16_bf16 v[192:207], v[128:131], v[80:83], v[192:207]
    v_mfma_f32_32x32x16_bf16 v[208:223], v[128:131], v[84:87], v[208:223]
    v_mfma_f32_32x32x16_bf16 v[224:239], v[132:135], v[80:83], v[224:239]
    v_mfma_f32_32x32x16_bf16 v[240:255], v[132:135], v[84:87], v[240:255]
    s_add_u32 s58, s64, 26624
    buffer_load_dwordx4 v[80:83], v17, s[44:47], s58 offen sc1
    s_add_u32 s58, s64, 141312
    buffer_load_dwordx4 v[84:87], v17, s[44:47], s58 offen sc1
    s_waitcnt vmcnt(10)
    v_mfma_f32_32x32x16_bf16 v[192:207], v[136:139], v[40:43], v[192:207]
    v_mfma_f32_32x32x16_bf16 v[208:223], v[136:139], v[44:47], v[208:223]
    v_mfma_f32_32x32x16_bf16 v[224:239], v[140:143], v[40:43], v[224:239]
    v_mfma_f32_32x32x16_bf16 v[240:255], v[140:143], v[44:47], v[240:255]
    s_add_u32 s58, s64, 27648
    buffer_load_dwordx4 v[40:43], v17, s[44:47], s58 offen sc1
    s_add_u32 s58, s64, 142336
    buffer_load_dwordx4 v[44:47], v17, s[44:47], s58 offen sc1
    s_waitcnt vmcnt(10)
    v_mfma_f32_32x32x16_bf16 v[192:207], v[144:147], v[48:51], v[192:207]
    v_mfma_f32_32x32x16_bf16 v[208:223], v[144:147], v[52:55], v[208:223]
    v_mfma_f32_32x32x16_bf16 v[224:239], v[148:151], v[48:51], v[224:239]
    v_mfma_f32_32x32x16_bf16 v[240:255], v[148:151], v[52:55], v[240:255]
    s_add_u32 s58, s64, 0
    buffer_load_dwordx4 v[48:51], v17, s[44:47], s58 offen sc1
    s_add_u32 s58, s64, 114688
    buffer_load_dwordx4 v[52:55], v17, s[44:47], s58 offen sc1
    s_waitcnt vmcnt(10)
    v_mfma_f32_32x32x16_bf16 v[192:207], v[152:155], v[56:59], v[192:207]
    v_mfma_f32_32x32x16_bf16 v[208:223], v[152:155], v[60:63], v[208:223]
    v_mfma_f32_32x32x16_bf16 v[224:239], v[156:159], v[56:59], v[224:239]
    v_mfma_f32_32x32x16_bf16 v[240:255], v[156:159], v[60:63], v[240:255]
    s_add_u32 s58, s64, 1024
    buffer_load_dwordx4 v[56:59], v17, s[44:47], s58 offen sc1
    s_add_u32 s58, s64, 115712
    buffer_load_dwordx4 v[60:63], v17, s[44:47], s58 offen sc1
    s_waitcnt vmcnt(10)
    v_mfma_f32_32x32x16_bf16 v[192:207], v[160:163], v[64:67], v[192:207]
    v_mfma_f32_32x32x16_bf16 v[208:223], v[160:163], v[68:71], v[208:223]
    v_mfma_f32_32x32x16_bf16 v[224:239], v[164:167], v[64:67], v[224:239]
    v_mfma_f32_32x32x16_bf16 v[240:255], v[164:167], v[68:71], v[240:255]
    s_add_u32 s58, s64, 2048
    buffer_load_dwordx4 v[64:67], v17, s[44:47], s58 offen sc1
    s_add_u32 s58, s64, 116736
    buffer_load_dwordx4 v[68:71], v17, s[44:47], s58 offen sc1
    s_waitcnt vmcnt(10)
    v_mfma_f32_32x32x16_bf16 v[192:207], v[168:171], v[72:75], v[192:207]
    v_mfma_f32_32x32x16_bf16 v[208:223], v[168:171], v[76:79], v[208:223]
    v_mfma_f32_32x32x16_bf16 v[224:239], v[172:175], v[72:75], v[224:239]
    v_mfma_f32_32x32x16_bf16 v[240:255], v[172:175], v[76:79], v[240:255]
    s_add_u32 s58, s64, 3072
    buffer_load_dwordx4 v[72:75], v17, s[44:47], s58 offen sc1
    s_add_u32 s58, s64, 117760
    buffer_load_dwordx4 v[76:79], v17, s[44:47], s58 offen sc1
    s_waitcnt vmcnt(10)
    v_mfma_f32_32x32x16_bf16 v[192:207], v[176:179], v[80:83], v[192:207]
    v_mfma_f32_32x32x16_bf16 v[208:223], v[176:179], v[84:87], v[208:223]
    v_mfma_f32_32x32x16_bf16 v[224:239], v[180:183], v[80:83], v[224:239]
    v_mfma_f32_32x32x16_bf16 v[240:255], v[180:183], v[84:87], v[240:255]
    s_add_u32 s58, s64, 4096
    buffer_load_dwordx4 v[80:83], v17, s[44:47], s58 offen sc1
    s_add_u32 s58, s64, 118784
    buffer_load_dwordx4 v[84:87], v17, s[44:47], s58 offen sc1
    s_waitcnt vmcnt(10)
    v_mfma_f32_32x32x16_bf16 v[192:207], v[184:187], v[40:43], v[192:207]
    ds_read_b64_tr_b16 v[32:33], v22 offset:0
    v_mfma_f32_32x32x16_bf16 v[208:223], v[184:187], v[44:47], v[208:223]
    ds_read_b64_tr_b16 v[34:35], v22 offset:1024
    v_mfma_f32_32x32x16_bf16 v[224:239], v[188:191], v[40:43], v[224:239]
    ds_read_b64_tr_b16 v[36:37], v23 offset:0
    v_mfma_f32_32x32x16_bf16 v[240:255], v[188:191], v[44:47], v[240:255]
    ds_read_b64_tr_b16 v[38:39], v23 offset:1024
    s_add_u32 s58, s64, 5120
    buffer_load_dwordx4 v[40:43], v17, s[44:47], s58 offen sc1
    s_add_u32 s58, s64, 119808
    buffer_load_dwordx4 v[44:47], v17, s[44:47], s58 offen sc1
    s_waitcnt vmcnt(10)
    s_waitcnt lgkmcnt(0)
    v_mfma_f32_32x32x16_bf16 v[192:207], v[32:35], v[48:51], v[192:207]
    ds_read_b64_tr_b16 v[24:25], v22 offset:2048
    v_mfma_f32_32x32x16_bf16 v[208:223], v[32:35], v[52:55], v[208:223]
    ds_read_b64_tr_b16 v[26:27], v22 offset:3072
    v_mfma_f32_32x32x16_bf16 v[224:239], v[36:39], v[48:51], v[224:239]
    ds_read_b64_tr_b16 v[28:29], v23 offset:2048
    v_mfma_f32_32x32x16_bf16 v[240:255], v[36:39], v[52:55], v[240:255]
    ds_read_b64_tr_b16 v[30:31], v23 offset:3072
    s_add_u32 s58, s64, 6144
    buffer_load_dwordx4 v[48:51], v17, s[44:47], s58 offen sc1
    s_add_u32 s58, s64, 120832
    buffer_load_dwordx4 v[52:55], v17, s[44:47], s58 offen sc1
    s_waitcnt vmcnt(10)
    s_waitcnt lgkmcnt(0)
    v_mfma_f32_32x32x16_bf16 v[192:207], v[24:27], v[56:59], v[192:207]
    ds_read_b64_tr_b16 v[32:33], v22 offset:4096
    v_mfma_f32_32x32x16_bf16 v[208:223], v[24:27], v[60:63], v[208:223]
    ds_read_b64_tr_b16 v[34:35], v22 offset:5120
    v_mfma_f32_32x32x16_bf16 v[224:239], v[28:31], v[56:59], v[224:239]
    ds_read_b64_tr_b16 v[36:37], v23 offset:4096
    v_mfma_f32_32x32x16_bf16 v[240:255], v[28:31], v[60:63], v[240:255]
    ds_read_b64_tr_b16 v[38:39], v23 offset:5120
    s_add_u32 s58, s64, 7168
    buffer_load_dwordx4 v[56:59], v17, s[44:47], s58 offen sc1
    s_add_u32 s58, s64, 121856
    buffer_load_dwordx4 v[60:63], v17, s[44:47], s58 offen sc1
    s_waitcnt vmcnt(10)
    s_waitcnt lgkmcnt(0)
    v_mfma_f32_32x32x16_bf16 v[192:207], v[32:35], v[64:67], v[192:207]
    ds_read_b64_tr_b16 v[24:25], v22 offset:6144
    v_mfma_f32_32x32x16_bf16 v[208:223], v[32:35], v[68:71], v[208:223]
    ds_read_b64_tr_b16 v[26:27], v22 offset:7168
    v_mfma_f32_32x32x16_bf16 v[224:239], v[36:39], v[64:67], v[224:239]
    ds_read_b64_tr_b16 v[28:29], v23 offset:6144
    v_mfma_f32_32x32x16_bf16 v[240:255], v[36:39], v[68:71], v[240:255]
    ds_read_b64_tr_b16 v[30:31], v23 offset:7168
    s_add_u32 s58, s64, 8192
    buffer_load_dwordx4 v[64:67], v17, s[44:47], s58 offen sc1
    s_add_u32 s58, s64, 122880
    buffer_load_dwordx4 v[68:71], v17, s[44:47], s58 offen sc1
    s_waitcnt vmcnt(10)
    s_waitcnt lgkmcnt(0)
    v_mfma_f32_32x32x16_bf16 v[192:207], v[24:27], v[72:75], v[192:207]
    ds_read_b64_tr_b16 v[32:33], v22 offset:8192
    v_mfma_f32_32x32x16_bf16 v[208:223], v[24:27], v[76:79], v[208:223]
    ds_read_b64_tr_b16 v[34:35], v22 offset:9216
    v_mfma_f32_32x32x16_bf16 v[224:239], v[28:31], v[72:75], v[224:239]
    ds_read_b64_tr_b16 v[36:37], v23 offset:8192
    v_mfma_f32_32x32x16_bf16 v[240:255], v[28:31], v[76:79], v[240:255]
    ds_read_b64_tr_b16 v[38:39], v23 offset:9216
    s_add_u32 s58, s64, 9216
    buffer_load_dwordx4 v[72:75], v17, s[44:47], s58 offen sc1
    s_add_u32 s58, s64, 123904
    buffer_load_dwordx4 v[76:79], v17, s[44:47], s58 offen sc1
    s_waitcnt vmcnt(10)
    s_waitcnt lgkmcnt(0)
    v_mfma_f32_32x32x16_bf16 v[192:207], v[32:35], v[80:83], v[192:207]
    ds_read_b64_tr_b16 v[24:25], v22 offset:10240
    v_mfma_f32_32x32x16_bf16 v[208:223], v[32:35], v[84:87], v[208:223]
    ds_read_b64_tr_b16 v[26:27], v22 offset:11264
    v_mfma_f32_32x32x16_bf16 v[224:239], v[36:39], v[80:83], v[224:239]
    ds_read_b64_tr_b16 v[28:29], v23 offset:10240
    v_mfma_f32_32x32x16_bf16 v[240:255], v[36:39], v[84:87], v[240:255]
    ds_read_b64_tr_b16 v[30:31], v23 offset:11264
    s_add_u32 s58, s64, 10240
    buffer_load_dwordx4 v[80:83], v17, s[44:47], s58 offen sc1
    s_add_u32 s58, s64, 124928
    buffer_load_dwordx4 v[84:87], v17, s[44:47], s58 offen sc1
    s_waitcnt vmcnt(10)
    s_waitcnt lgkmcnt(0)
    v_mfma_f32_32x32x16_bf16 v[192:207], v[24:27], v[40:43], v[192:207]
    ds_read_b64_tr_b16 v[32:33], v22 offset:12288
    v_mfma_f32_32x32x16_bf16 v[208:223], v[24:27], v[44:47], v[208:223]
    ds_read_b64_tr_b16 v[34:35], v22 offset:13312
    v_mfma_f32_32x32x16_bf16 v[224:239], v[28:31], v[40:43], v[224:239]
    ds_read_b64_tr_b16 v[36:37], v23 offset:12288
    v_mfma_f32_32x32x16_bf16 v[240:255], v[28:31], v[44:47], v[240:255]
    ds_read_b64_tr_b16 v[38:39], v23 offset:13312
    s_add_u32 s58, s64, 11264
    buffer_load_dwordx4 v[40:43], v17, s[44:47], s58 offen sc1
    s_add_u32 s58, s64, 125952
    buffer_load_dwordx4 v[44:47], v17, s[44:47], s58 offen sc1
    s_waitcnt vmcnt(10)
    s_waitcnt lgkmcnt(0)
    v_mfma_f32_32x32x16_bf16 v[192:207], v[32:35], v[48:51], v[192:207]
    ds_read_b64_tr_b16 v[24:25], v22 offset:14336
    v_mfma_f32_32x32x16_bf16 v[208:223], v[32:35], v[52:55], v[208:223]
    ds_read_b64_tr_b16 v[26:27], v22 offset:15360
    v_mfma_f32_32x32x16_bf16 v[224:239], v[36:39], v[48:51], v[224:239]
    ds_read_b64_tr_b16 v[28:29], v23 offset:14336
    v_mfma_f32_32x32x16_bf16 v[240:255], v[36:39], v[52:55], v[240:255]
    ds_read_b64_tr_b16 v[30:31], v23 offset:15360
    s_add_u32 s58, s64, 12288
    buffer_load_dwordx4 v[48:51], v17, s[44:47], s58 offen sc1
    s_add_u32 s58, s64, 126976
    buffer_load_dwordx4 v[52:55], v17, s[44:47], s58 offen sc1
    s_waitcnt vmcnt(10)
    s_waitcnt lgkmcnt(0)
    v_mfma_f32_32x32x16_bf16 v[192:207], v[24:27], v[56:59], v[192:207]
    ds_read_b64_tr_b16 v[32:33], v22 offset:16384
    v_mfma_f32_32x32x16_bf16 v[208:223], v[24:27], v[60:63], v[208:223]
    ds_read_b64_tr_b16 v[34:35], v22 offset:17408
    v_mfma_f32_32x32x16_bf16 v[224:239], v[28:31], v[56:59], v[224:239]
    ds_read_b64_tr_b16 v[36:37], v23 offset:16384
    v_mfma_f32_32x32x16_bf16 v[240:255], v[28:31], v[60:63], v[240:255]
    ds_read_b64_tr_b16 v[38:39], v23 offset:17408
    s_add_u32 s58, s64, 13312
    buffer_load_dwordx4 v[56:59], v17, s[44:47], s58 offen sc1
    s_add_u32 s58, s64, 128000
    buffer_load_dwordx4 v[60:63], v17, s[44:47], s58 offen sc1
    s_waitcnt vmcnt(10)
    s_waitcnt lgkmcnt(0)
    v_mfma_f32_32x32x16_bf16 v[192:207], v[32:35], v[64:67], v[192:207]
    ds_read_b64_tr_b16 v[24:25], v22 offset:18432
    v_mfma_f32_32x32x16_bf16 v[208:223], v[32:35], v[68:71], v[208:223]
    ds_read_b64_tr_b16 v[26:27], v22 offset:19456
    v_mfma_f32_32x32x16_bf16 v[224:239], v[36:39], v[64:67], v[224:239]
    ds_read_b64_tr_b16 v[28:29], v23 offset:18432
    v_mfma_f32_32x32x16_bf16 v[240:255], v[36:39], v[68:71], v[240:255]
    ds_read_b64_tr_b16 v[30:31], v23 offset:19456
    s_add_u32 s58, s64, 14336
    buffer_load_dwordx4 v[64:67], v17, s[44:47], s58 offen sc1
    s_add_u32 s58, s64, 129024
    buffer_load_dwordx4 v[68:71], v17, s[44:47], s58 offen sc1
    s_waitcnt vmcnt(10)
    s_waitcnt lgkmcnt(0)
    v_mfma_f32_32x32x16_bf16 v[192:207], v[24:27], v[72:75], v[192:207]
    ds_read_b64_tr_b16 v[32:33], v22 offset:20480
    v_mfma_f32_32x32x16_bf16 v[208:223], v[24:27], v[76:79], v[208:223]
    ds_read_b64_tr_b16 v[34:35], v22 offset:21504
    v_mfma_f32_32x32x16_bf16 v[224:239], v[28:31], v[72:75], v[224:239]
    ds_read_b64_tr_b16 v[36:37], v23 offset:20480
    v_mfma_f32_32x32x16_bf16 v[240:255], v[28:31], v[76:79], v[240:255]
    ds_read_b64_tr_b16 v[38:39], v23 offset:21504
    s_waitcnt vmcnt(8)
    s_waitcnt lgkmcnt(0)
    v_mfma_f32_32x32x16_bf16 v[192:207], v[32:35], v[80:83], v[192:207]
    ds_read_b64_tr_b16 v[24:25], v22 offset:22528
    v_mfma_f32_32x32x16_bf16 v[208:223], v[32:35], v[84:87], v[208:223]
    ds_read_b64_tr_b16 v[26:27], v22 offset:23552
    v_mfma_f32_32x32x16_bf16 v[224:239], v[36:39], v[80:83], v[224:239]
    ds_read_b64_tr_b16 v[28:29], v23 offset:22528
    v_mfma_f32_32x32x16_bf16 v[240:255], v[36:39], v[84:87], v[240:255]
    ds_read_b64_tr_b16 v[30:31], v23 offset:23552
    s_waitcnt vmcnt(6)
    s_waitcnt lgkmcnt(0)
    v_mfma_f32_32x32x16_bf16 v[192:207], v[24:27], v[40:43], v[192:207]
    ds_read_b64_tr_b16 v[32:33], v22 offset:24576
    v_mfma_f32_32x32x16_bf16 v[208:223], v[24:27], v[44:47], v[208:223]
    ds_read_b64_tr_b16 v[34:35], v22 offset:25600
    v_mfma_f32_32x32x16_bf16 v[224:239], v[28:31], v[40:43], v[224:239]
    ds_read_b64_tr_b16 v[36:37], v23 offset:24576
    v_mfma_f32_32x32x16_bf16 v[240:255], v[28:31], v[44:47], v[240:255]
    ds_read_b64_tr_b16 v[38:39], v23 offset:25600
    s_waitcnt vmcnt(4)
    s_waitcnt lgkmcnt(0)
    v_mfma_f32_32x32x16_bf16 v[192:207], v[32:35], v[48:51], v[192:207]
    ds_read_b64_tr_b16 v[24:25], v22 offset:26624
    v_mfma_f32_32x32x16_bf16 v[208:223], v[32:35], v[52:55], v[208:223]
    ds_read_b64_tr_b16 v[26:27], v22 offset:27648
    v_mfma_f32_32x32x16_bf16 v[224:239], v[36:39], v[48:51], v[224:239]
    ds_read_b64_tr_b16 v[28:29], v23 offset:26624
    v_mfma_f32_32x32x16_bf16 v[240:255], v[36:39], v[52:55], v[240:255]
    ds_read_b64_tr_b16 v[30:31], v23 offset:27648
    s_waitcnt vmcnt(2)
    s_waitcnt lgkmcnt(0)
    v_mfma_f32_32x32x16_bf16 v[192:207], v[24:27], v[56:59], v[192:207]
    ds_read_b64_tr_b16 v[32:33], v22 offset:28672
    v_mfma_f32_32x32x16_bf16 v[208:223], v[24:27], v[60:63], v[208:223]
    ds_read_b64_tr_b16 v[34:35], v22 offset:29696
    v_mfma_f32_32x32x16_bf16 v[224:239], v[28:31], v[56:59], v[224:239]
    ds_read_b64_tr_b16 v[36:37], v23 offset:28672
    v_mfma_f32_32x32x16_bf16 v[240:255], v[28:31], v[60:63], v[240:255]
    ds_read_b64_tr_b16 v[38:39], v23 offset:29696
    s_waitcnt vmcnt(0)
    s_waitcnt lgkmcnt(0)
    v_mfma_f32_32x32x16_bf16 v[192:207], v[32:35], v[64:67], v[192:207]
    v_mfma_f32_32x32x16_bf16 v[208:223], v[32:35], v[68:71], v[208:223]
    v_mfma_f32_32x32x16_bf16 v[224:239], v[36:39], v[64:67], v[224:239]
    v_mfma_f32_32x32x16_bf16 v[240:255], v[36:39], v[68:71], v[240:255]
    v_and_b32 v4, 31, v0
    v_mul_u32_u24 v4, 272, v4
    v_lshrrev_b32 v5, 5, v0
    v_lshl_add_u32 v4, v5, 4, v4
    v_add_u32 v4, s66, v4
    s_nop 7
    ds_write_b128 v4, v[192:195] offset:0
    ds_write_b128 v4, v[196:199] offset:32
    ds_write_b128 v4, v[200:203] offset:64
    ds_write_b128 v4, v[204:207] offset:96
    ds_write_b128 v4, v[208:211] offset:8704
    ds_write_b128 v4, v[212:215] offset:8736
    ds_write_b128 v4, v[216:219] offset:8768
    ds_write_b128 v4, v[220:223] offset:8800
    ds_write_b128 v4, v[224:227] offset:128
    ds_write_b128 v4, v[228:231] offset:160
    ds_write_b128 v4, v[232:235] offset:192
    ds_write_b128 v4, v[236:239] offset:224
    ds_write_b128 v4, v[240:243] offset:8832
    ds_write_b128 v4, v[244:247] offset:8864
    ds_write_b128 v4, v[248:251] offset:8896
    ds_write_b128 v4, v[252:255] offset:8928
    s_waitcnt lgkmcnt(0)
    s_barrier
L_cout:
    s_endpgm
L_prep:
    v_lshrrev_b32 v4, 4, v0
    v_mul_u32_u24 v4, 3584, v4
    v_and_b32 v5, 15, v0
    v_lshl_add_u32 v14, v5, 4, v4
    v_lshlrev_b32 v15, 4, v0
    s_waitcnt lgkmcnt(0)
    s_mov_b32 s44, s28
    s_and_b32 s45, s29, 0xffff
    s_mov_b32 s46, 268435456
    s_mov_b32 s47, 0x20000
    s_mov_b32 s32, s12
    s_and_b32 s33, s13, 0xffff
    s_mov_b32 s34, 1835008
    s_mov_b32 s35, 0x20000
    s_mov_b32 s36, s22
    s_and_b32 s37, s23, 0xffff
    s_mov_b32 s38, 1605632
    s_mov_b32 s39, 0x20000
    s_cmp_ge_u32 s2, 28
    s_cbranch_scc1 L_aux_nocs
    s_cmp_ge_u32 s2, 14
    s_cbranch_scc1 L_aux_up
    s_mov_b32 s48, s18
    s_and_b32 s49, s19, 0xffff
    s_mov_b32 s50, 1605632
    s_mov_b32 s51, 0x20000
    s_mov_b32 s63, s2
    s_branch L_aux_cs
L_aux_up:
    s_mov_b32 s48, s20
    s_and_b32 s49, s21, 0xffff
    s_mov_b32 s50, 1605632
    s_mov_b32 s51, 0x20000
    s_sub_u32 s63, s2, 14
L_aux_cs:
    v_mov_b32 v5, 11403264
    buffer_load_dword v12, v5, s[44:47], 0 offen sc1
    s_mul_i32 s58, s30, 14336
    s_lshl_b32 s59, s63, 8
    s_add_u32 s58, s58, s59
    buffer_load_dwordx4 v[192:195], v14, s[48:51], s58 offen
    s_add_u32 s58, s58, 114688
    buffer_load_dwordx4 v[196:199], v14, s[48:51], s58 offen
    s_add_u32 s58, s58, 114688
    buffer_load_dwordx4 v[200:203], v14, s[48:51], s58 offen
    s_add_u32 s58, s58, 114688
    buffer_load_dwordx4 v[204:207], v14, s[48:51], s58 offen
    s_add_u32 s58, s58, 114688
    buffer_load_dwordx4 v[208:211], v14, s[48:51], s58 offen
    s_add_u32 s58, s58, 114688
    buffer_load_dwordx4 v[212:215], v14, s[48:51], s58 offen
    s_add_u32 s58, s58, 114688
    buffer_load_dwordx4 v[216:219], v14, s[48:51], s58 offen
    s_add_u32 s58, s58, 114688
    buffer_load_dwordx4 v[220:223], v14, s[48:51], s58 offen
    s_add_u32 s58, s58, 114688
    buffer_load_dwordx4 v[224:227], v14, s[48:51], s58 offen
    s_add_u32 s58, s58, 114688
    buffer_load_dwordx4 v[228:231], v14, s[48:51], s58 offen
    s_add_u32 s58, s58, 114688
    buffer_load_dwordx4 v[232:235], v14, s[48:51], s58 offen
    s_add_u32 s58, s58, 114688
    buffer_load_dwordx4 v[236:239], v14, s[48:51], s58 offen
    s_add_u32 s58, s58, 114688
    buffer_load_dwordx4 v[240:243], v14, s[48:51], s58 offen
    s_add_u32 s58, s58, 114688
    buffer_load_dwordx4 v[244:247], v14, s[48:51], s58 offen
    s_mov_b32 s64, 0x00003f80
    s_mov_b32 s65, 0x3f800000
    s_waitcnt vmcnt(13)
    v_dot2_f32_bf16 v248, v192, s64, 0
    v_dot2_f32_bf16 v249, v192, s65, 0
    v_dot2_f32_bf16 v250, v193, s64, 0
    v_dot2_f32_bf16 v251, v193, s65, 0
    v_dot2_f32_bf16 v252, v194, s64, 0
    v_dot2_f32_bf16 v253, v194, s65, 0
    v_dot2_f32_bf16 v254, v195, s64, 0
    v_dot2_f32_bf16 v255, v195, s65, 0
    s_waitcnt vmcnt(12)
    v_dot2_f32_bf16 v248, v196, s64, v248
    v_dot2_f32_bf16 v249, v196, s65, v249
    v_dot2_f32_bf16 v250, v197, s64, v250
    v_dot2_f32_bf16 v251, v197, s65, v251
    v_dot2_f32_bf16 v252, v198, s64, v252
    v_dot2_f32_bf16 v253, v198, s65, v253
    v_dot2_f32_bf16 v254, v199, s64, v254
    v_dot2_f32_bf16 v255, v199, s65, v255
    s_waitcnt vmcnt(11)
    v_dot2_f32_bf16 v248, v200, s64, v248
    v_dot2_f32_bf16 v249, v200, s65, v249
    v_dot2_f32_bf16 v250, v201, s64, v250
    v_dot2_f32_bf16 v251, v201, s65, v251
    v_dot2_f32_bf16 v252, v202, s64, v252
    v_dot2_f32_bf16 v253, v202, s65, v253
    v_dot2_f32_bf16 v254, v203, s64, v254
    v_dot2_f32_bf16 v255, v203, s65, v255
    s_waitcnt vmcnt(10)
    v_dot2_f32_bf16 v248, v204, s64, v248
    v_dot2_f32_bf16 v249, v204, s65, v249
    v_dot2_f32_bf16 v250, v205, s64, v250
    v_dot2_f32_bf16 v251, v205, s65, v251
    v_dot2_f32_bf16 v252, v206, s64, v252
    v_dot2_f32_bf16 v253, v206, s65, v253
    v_dot2_f32_bf16 v254, v207, s64, v254
    v_dot2_f32_bf16 v255, v207, s65, v255
    s_waitcnt vmcnt(9)
    v_dot2_f32_bf16 v248, v208, s64, v248
    v_dot2_f32_bf16 v249, v208, s65, v249
    v_dot2_f32_bf16 v250, v209, s64, v250
    v_dot2_f32_bf16 v251, v209, s65, v251
    v_dot2_f32_bf16 v252, v210, s64, v252
    v_dot2_f32_bf16 v253, v210, s65, v253
    v_dot2_f32_bf16 v254, v211, s64, v254
    v_dot2_f32_bf16 v255, v211, s65, v255
    s_waitcnt vmcnt(8)
    v_dot2_f32_bf16 v248, v212, s64, v248
    v_dot2_f32_bf16 v249, v212, s65, v249
    v_dot2_f32_bf16 v250, v213, s64, v250
    v_dot2_f32_bf16 v251, v213, s65, v251
    v_dot2_f32_bf16 v252, v214, s64, v252
    v_dot2_f32_bf16 v253, v214, s65, v253
    v_dot2_f32_bf16 v254, v215, s64, v254
    v_dot2_f32_bf16 v255, v215, s65, v255
    s_waitcnt vmcnt(7)
    v_dot2_f32_bf16 v248, v216, s64, v248
    v_dot2_f32_bf16 v249, v216, s65, v249
    v_dot2_f32_bf16 v250, v217, s64, v250
    v_dot2_f32_bf16 v251, v217, s65, v251
    v_dot2_f32_bf16 v252, v218, s64, v252
    v_dot2_f32_bf16 v253, v218, s65, v253
    v_dot2_f32_bf16 v254, v219, s64, v254
    v_dot2_f32_bf16 v255, v219, s65, v255
    s_waitcnt vmcnt(6)
    v_dot2_f32_bf16 v248, v220, s64, v248
    v_dot2_f32_bf16 v249, v220, s65, v249
    v_dot2_f32_bf16 v250, v221, s64, v250
    v_dot2_f32_bf16 v251, v221, s65, v251
    v_dot2_f32_bf16 v252, v222, s64, v252
    v_dot2_f32_bf16 v253, v222, s65, v253
    v_dot2_f32_bf16 v254, v223, s64, v254
    v_dot2_f32_bf16 v255, v223, s65, v255
    s_waitcnt vmcnt(5)
    v_dot2_f32_bf16 v248, v224, s64, v248
    v_dot2_f32_bf16 v249, v224, s65, v249
    v_dot2_f32_bf16 v250, v225, s64, v250
    v_dot2_f32_bf16 v251, v225, s65, v251
    v_dot2_f32_bf16 v252, v226, s64, v252
    v_dot2_f32_bf16 v253, v226, s65, v253
    v_dot2_f32_bf16 v254, v227, s64, v254
    v_dot2_f32_bf16 v255, v227, s65, v255
    s_waitcnt vmcnt(4)
    v_dot2_f32_bf16 v248, v228, s64, v248
    v_dot2_f32_bf16 v249, v228, s65, v249
    v_dot2_f32_bf16 v250, v229, s64, v250
    v_dot2_f32_bf16 v251, v229, s65, v251
    v_dot2_f32_bf16 v252, v230, s64, v252
    v_dot2_f32_bf16 v253, v230, s65, v253
    v_dot2_f32_bf16 v254, v231, s64, v254
    v_dot2_f32_bf16 v255, v231, s65, v255
    s_waitcnt vmcnt(3)
    v_dot2_f32_bf16 v248, v232, s64, v248
    v_dot2_f32_bf16 v249, v232, s65, v249
    v_dot2_f32_bf16 v250, v233, s64, v250
    v_dot2_f32_bf16 v251, v233, s65, v251
    v_dot2_f32_bf16 v252, v234, s64, v252
    v_dot2_f32_bf16 v253, v234, s65, v253
    v_dot2_f32_bf16 v254, v235, s64, v254
    v_dot2_f32_bf16 v255, v235, s65, v255
    s_waitcnt vmcnt(2)
    v_dot2_f32_bf16 v248, v236, s64, v248
    v_dot2_f32_bf16 v249, v236, s65, v249
    v_dot2_f32_bf16 v250, v237, s64, v250
    v_dot2_f32_bf16 v251, v237, s65, v251
    v_dot2_f32_bf16 v252, v238, s64, v252
    v_dot2_f32_bf16 v253, v238, s65, v253
    v_dot2_f32_bf16 v254, v239, s64, v254
    v_dot2_f32_bf16 v255, v239, s65, v255
    s_waitcnt vmcnt(1)
    v_dot2_f32_bf16 v248, v240, s64, v248
    v_dot2_f32_bf16 v249, v240, s65, v249
    v_dot2_f32_bf16 v250, v241, s64, v250
    v_dot2_f32_bf16 v251, v241, s65, v251
    v_dot2_f32_bf16 v252, v242, s64, v252
    v_dot2_f32_bf16 v253, v242, s65, v253
    v_dot2_f32_bf16 v254, v243, s64, v254
    v_dot2_f32_bf16 v255, v243, s65, v255
    s_waitcnt vmcnt(0)
    v_dot2_f32_bf16 v248, v244, s64, v248
    v_dot2_f32_bf16 v249, v244, s65, v249
    v_dot2_f32_bf16 v250, v245, s64, v250
    v_dot2_f32_bf16 v251, v245, s65, v251
    v_dot2_f32_bf16 v252, v246, s64, v252
    v_dot2_f32_bf16 v253, v246, s65, v253
    v_dot2_f32_bf16 v254, v247, s64, v254
    v_dot2_f32_bf16 v255, v247, s65, v255
    v_lshrrev_b32 v4, 4, v0
    s_lshl_b32 s58, s30, 2
    v_add_u32 v4, s58, v4
    v_lshlrev_b32 v4, 9, v4
    v_and_b32 v5, 15, v0
    v_lshl_add_u32 v4, v5, 5, v4
    ds_write_b128 v4, v[248:251]
    ds_write_b128 v4, v[252:255] offset:16
    s_waitcnt lgkmcnt(0)
    s_barrier
    s_cmp_lg_u32 s30, 7
    s_cbranch_scc1 L_aux_touch
    v_lshlrev_b32 v4, 2, v0
    ds_read_b32 v128, v4 offset:0
    ds_read_b32 v129, v4 offset:512
    ds_read_b32 v130, v4 offset:1024
    ds_read_b32 v131, v4 offset:1536
    ds_read_b32 v132, v4 offset:2048
    ds_read_b32 v133, v4 offset:2560
    ds_read_b32 v134, v4 offset:3072
    ds_read_b32 v135, v4 offset:3584
    s_waitcnt lgkmcnt(7)
    ds_read_b32 v136, v4 offset:4096
    ds_read_b32 v137, v4 offset:4608
    ds_read_b32 v138, v4 offset:5120
    ds_read_b32 v139, v4 offset:5632
    ds_read_b32 v140, v4 offset:6144
    ds_read_b32 v141, v4 offset:6656
    ds_read_b32 v142, v4 offset:7168
    ds_read_b32 v143, v4 offset:7680
    s_waitcnt lgkmcnt(7)
    ds_read_b32 v144, v4 offset:8192
    ds_read_b32 v145, v4 offset:8704
    ds_read_b32 v146, v4 offset:9216
    ds_read_b32 v147, v4 offset:9728
    ds_read_b32 v148, v4 offset:10240
    ds_read_b32 v149, v4 offset:10752
    ds_read_b32 v150, v4 offset:11264
    ds_read_b32 v151, v4 offset:11776
    s_waitcnt lgkmcnt(7)
    ds_read_b32 v152, v4 offset:12288
    ds_read_b32 v153, v4 offset:12800
    ds_read_b32 v154, v4 offset:13312
    ds_read_b32 v155, v4 offset:13824
    ds_read_b32 v156, v4 offset:14336
    ds_read_b32 v157, v4 offset:14848
    ds_read_b32 v158, v4 offset:15360
    ds_read_b32 v159, v4 offset:15872
    s_waitcnt lgkmcnt(7)
    ds_read_b32 v160, v4 offset:256
    ds_read_b32 v161, v4 offset:768
    ds_read_b32 v162, v4 offset:1280
    ds_read_b32 v163, v4 offset:1792
    ds_read_b32 v164, v4 offset:2304
    ds_read_b32 v165, v4 offset:2816
    ds_read_b32 v166, v4 offset:3328
    ds_read_b32 v167, v4 offset:3840
    s_waitcnt lgkmcnt(7)
    ds_read_b32 v168, v4 offset:4352
    ds_read_b32 v169, v4 offset:4864
    ds_read_b32 v170, v4 offset:5376
    ds_read_b32 v171, v4 offset:5888
    ds_read_b32 v172, v4 offset:6400
    ds_read_b32 v173, v4 offset:6912
    ds_read_b32 v174, v4 offset:7424
    ds_read_b32 v175, v4 offset:7936
    s_waitcnt lgkmcnt(7)
    ds_read_b32 v176, v4 offset:8448
    ds_read_b32 v177, v4 offset:8960
    ds_read_b32 v178, v4 offset:9472
    ds_read_b32 v179, v4 offset:9984
    ds_read_b32 v180, v4 offset:10496
    ds_read_b32 v181, v4 offset:11008
    ds_read_b32 v182, v4 offset:11520
    ds_read_b32 v183, v4 offset:12032
    s_waitcnt lgkmcnt(7)
    ds_read_b32 v184, v4 offset:12544
    ds_read_b32 v185, v4 offset:13056
    ds_read_b32 v186, v4 offset:13568
    ds_read_b32 v187, v4 offset:14080
    ds_read_b32 v188, v4 offset:14592
    ds_read_b32 v189, v4 offset:15104
    ds_read_b32 v190, v4 offset:15616
    ds_read_b32 v191, v4 offset:16128
    s_waitcnt lgkmcnt(7)
    s_waitcnt lgkmcnt(0)
    v_readfirstlane_b32 s31, v12
    s_nop 3
    s_add_u32 s31, s31, 1
    v_add_f32 v128, v128, v144
    v_add_f32 v129, v129, v145
    v_add_f32 v130, v130, v146
    v_add_f32 v131, v131, v147
    v_add_f32 v132, v132, v148
    v_add_f32 v133, v133, v149
    v_add_f32 v134, v134, v150
    v_add_f32 v135, v135, v151
    v_add_f32 v136, v136, v152
    v_add_f32 v137, v137, v153
    v_add_f32 v138, v138, v154
    v_add_f32 v139, v139, v155
    v_add_f32 v140, v140, v156
    v_add_f32 v141, v141, v157
    v_add_f32 v142, v142, v158
    v_add_f32 v143, v143, v159
    v_add_f32 v128, v128, v136
    v_add_f32 v129, v129, v137
    v_add_f32 v130, v130, v138
    v_add_f32 v131, v131, v139
    v_add_f32 v132, v132, v140
    v_add_f32 v133, v133, v141
    v_add_f32 v134, v134, v142
    v_add_f32 v135, v135, v143
    v_add_f32 v128, v128, v132
    v_add_f32 v129, v129, v133
    v_add_f32 v130, v130, v134
    v_add_f32 v131, v131, v135
    v_add_f32 v128, v128, v130
    v_add_f32 v129, v129, v131
    v_add_f32 v128, v128, v129
    v_mov_b32 v129, s31
    v_add_f32 v160, v160, v176
    v_add_f32 v161, v161, v177
    v_add_f32 v162, v162, v178
    v_add_f32 v163, v163, v179
    v_add_f32 v164, v164, v180
    v_add_f32 v165, v165, v181
    v_add_f32 v166, v166, v182
    v_add_f32 v167, v167, v183
    v_add_f32 v168, v168, v184
    v_add_f32 v169, v169, v185
    v_add_f32 v170, v170, v186
    v_add_f32 v171, v171, v187
    v_add_f32 v172, v172, v188
    v_add_f32 v173, v173, v189
    v_add_f32 v174, v174, v190
    v_add_f32 v175, v175, v191
    v_add_f32 v160, v160, v168
    v_add_f32 v161, v161, v169
    v_add_f32 v162, v162, v170
    v_add_f32 v163, v163, v171
    v_add_f32 v164, v164, v172
    v_add_f32 v165, v165, v173
    v_add_f32 v166, v166, v174
    v_add_f32 v167, v167, v175
    v_add_f32 v160, v160, v164
    v_add_f32 v161, v161, v165
    v_add_f32 v162, v162, v166
    v_add_f32 v163, v163, v167
    v_add_f32 v160, v160, v162
    v_add_f32 v161, v161, v163
    v_add_f32 v160, v160, v161
    v_mov_b32 v161, s31
    s_cmp_ge_u32 s2, 14
    s_cselect_b32 s58, 1792, 0
    s_lshl_b32 s59, s63, 7
    s_add_u32 s58, s58, s59
    s_lshl_b32 s58, s58, 3
    s_add_u32 s58, s58, 11468800
    v_lshlrev_b32 v4, 3, v0
    buffer_store_dwordx2 v[128:129], v4, s[44:47], s58 offen sc1
    buffer_store_dwordx2 v[160:161], v4, s[44:47], s58 offen offset:512 sc1
    s_branch L_aux_touch
L_aux_nocs:
L_aux_touch:
    s_mul_i32 s58, s2, 57344
    s_lshl_b32 s59, s30, 10
    s_add_u32 s58, s58, s59
    buffer_load_dwordx4 v[16:19], v15, s[32:35], s58 offen
    s_add_u32 s58, s58, 8192
    buffer_load_dwordx4 v[20:23], v15, s[32:35], s58 offen
    s_add_u32 s58, s58, 8192
    buffer_load_dwordx4 v[24:27], v15, s[32:35], s58 offen
    s_add_u32 s58, s58, 8192
    buffer_load_dwordx4 v[28:31], v15, s[32:35], s58 offen
    s_add_u32 s58, s58, 8192
    buffer_load_dwordx4 v[32:35], v15, s[32:35], s58 offen
    s_add_u32 s58, s58, 8192
    buffer_load_dwordx4 v[36:39], v15, s[32:35], s58 offen
    s_add_u32 s58, s58, 8192
    buffer_load_dwordx4 v[40:43], v15, s[32:35], s58 offen
    s_add_u32 s58, s58, 8192
    s_mul_i32 s58, s2, 50176
    s_add_u32 s58, s58, s59
    buffer_load_dwordx4 v[48:51], v15, s[36:39], s58 offen
    s_add_u32 s58, s58, 8192
    buffer_load_dwordx4 v[52:55], v15, s[36:39], s58 offen
    s_add_u32 s58, s58, 8192
    buffer_load_dwordx4 v[56:59], v15, s[36:39], s58 offen
    s_add_u32 s58, s58, 8192
    buffer_load_dwordx4 v[60:63], v15, s[36:39], s58 offen
    s_add_u32 s58, s58, 8192
    buffer_load_dwordx4 v[64:67], v15, s[36:39], s58 offen
    s_add_u32 s58, s58, 8192
    buffer_load_dwordx4 v[68:71], v15, s[36:39], s58 offen
    s_add_u32 s58, s58, 8192
    buffer_load_dwordx4 v[72:75], v15, s[36:39], s58 offen
    s_add_u32 s58, s58, 8192
    s_waitcnt vmcnt(0)
    s_cmp_lg_u32 s2, 28
    s_cbranch_scc1 L_aux_end
    s_cmp_lg_u32 s30, 0
    s_cbranch_scc1 L_aux_end
    v_mov_b32 v5, 11403264
    buffer_load_dword v6, v5, s[44:47], 0 offen sc1
    s_waitcnt vmcnt(0)
    v_readfirstlane_b32 s31, v6
    s_nop 3
    s_add_u32 s31, s31, 1
    v_lshlrev_b32 v4, 2, v0
    v_add_u32 v4, 11272192, v4
    s_mov_b32 s68, 65536
L_aux_ep:
    s_sleep 32
    buffer_load_dword v16, v4, s[44:47], 0 offen offset:0 sc1
    buffer_load_dword v17, v4, s[44:47], 0 offen offset:256 sc1
    buffer_load_dword v18, v4, s[44:47], 0 offen offset:512 sc1
    buffer_load_dword v19, v4, s[44:47], 0 offen offset:768 sc1
    buffer_load_dword v20, v4, s[44:47], 0 offen offset:1024 sc1
    buffer_load_dword v21, v4, s[44:47], 0 offen offset:1280 sc1
    buffer_load_dword v22, v4, s[44:47], 0 offen offset:1536 sc1
    buffer_load_dword v23, v4, s[44:47], 0 offen offset:1792 sc1
    buffer_load_dword v24, v4, s[44:47], 0 offen offset:2048 sc1
    buffer_load_dword v25, v4, s[44:47], 0 offen offset:2304 sc1
    buffer_load_dword v26, v4, s[44:47], 0 offen offset:2560 sc1
    buffer_load_dword v27, v4, s[44:47], 0 offen offset:2816 sc1
    buffer_load_dword v28, v4, s[44:47], 0 offen offset:3072 sc1
    buffer_load_dword v29, v4, s[44:47], 0 offen offset:3328 sc1
    s_waitcnt vmcnt(0)
    v_xor_b32 v16, s31, v16
    v_xor_b32 v17, s31, v17
    v_xor_b32 v18, s31, v18
    v_xor_b32 v19, s31, v19
    v_xor_b32 v20, s31, v20
    v_xor_b32 v21, s31, v21
    v_xor_b32 v22, s31, v22
    v_xor_b32 v23, s31, v23
    v_xor_b32 v24, s31, v24
    v_xor_b32 v25, s31, v25
    v_xor_b32 v26, s31, v26
    v_xor_b32 v27, s31, v27
    v_xor_b32 v28, s31, v28
    v_xor_b32 v29, s31, v29
    v_or_b32 v16, v16, v17
    v_or_b32 v16, v16, v18
    v_or_b32 v16, v16, v19
    v_or_b32 v16, v16, v20
    v_or_b32 v16, v16, v21
    v_or_b32 v16, v16, v22
    v_or_b32 v16, v16, v23
    v_or_b32 v16, v16, v24
    v_or_b32 v16, v16, v25
    v_or_b32 v16, v16, v26
    v_or_b32 v16, v16, v27
    v_or_b32 v16, v16, v28
    v_or_b32 v16, v16, v29
    v_cmp_ne_u32 vcc, 0, v16
    s_nop 1
    s_cbranch_vccz L_aux_epw
    s_sub_u32 s68, s68, 1
    s_cmp_lg_u32 s68, 0
    s_cbranch_scc1 L_aux_ep
L_aux_epw:
    v_mov_b32 v6, s31
    s_mov_b64 exec, 1
    buffer_store_dword v6, v5, s[44:47], 0 offen sc1
    s_mov_b64 exec, -1
    s_waitcnt vmcnt(0)
L_aux_end:
    s_endpgm
L_end:
    s_endpgm
.section .rodata,"a"
.p2align 6
.amdhsa_kernel parallel_sum__ssm_conv_h3__glu_gated_reglu__prompt_kernel
  .amdhsa_next_free_vgpr 256
  .amdhsa_next_free_sgpr 102
  .amdhsa_accum_offset 256
  .amdhsa_group_segment_fixed_size 0
  .amdhsa_kernarg_size 104
  .amdhsa_user_sgpr_count 2
  .amdhsa_user_sgpr_kernarg_segment_ptr 1
  .amdhsa_system_sgpr_workgroup_id_x 1
  .amdhsa_float_denorm_mode_32 3
.end_amdhsa_kernel
```
